```python
import torch

def _softmax(x, axis=-1):
    return torch.softmax(x, dim=axis)
def _gelu(x):
    return torch.nn.functional.gelu(x, approximate="tanh")
def _silu(x):
    return torch.nn.functional.silu(x)
def _sigmoid(x):
    return torch.sigmoid(x)
def _layernorm(x, axis=-1, eps=1e-5):
    m = x.mean(dim=axis, keepdim=True)
    v = x.var(dim=axis, keepdim=True, unbiased=False)
    return (x - m) / torch.sqrt(v + eps)
def _scatter_add(tgt, idx, src, axis=0):
    return tgt.clone().index_add_(axis, idx, src)
def _segment_sum(src, seg, n):
    out = torch.zeros((n,) + src.shape[1:], dtype=src.dtype)
    return out.index_add_(0, seg, src)
def _pad(x, pw):
    flat = tuple(v for pair in reversed(pw) for v in pair)
    return torch.nn.functional.pad(x, flat)

kernel_name = 'gated_mix__grouped_kv_mqa__spectral_gfnet__prompt'

def setup_inputs():

    _w = (lambda a: (lambda t: t.to(torch.bfloat16) if t.is_floating_point() else t)(torch.as_tensor(a)))
    def _A_setup():
        B, S, D, H = 1, 2048, 512, 32
        Dh = D // H
        return {
            "x": _w((lambda *s: torch.randn(*s, dtype=torch.bfloat16) * 0.05)(B, S, D)),
            "wq": _w((lambda *s: torch.randn(*s, dtype=torch.bfloat16) * 0.8)(D, H * Dh)),
            "wk": _w((lambda *s: torch.randn(*s, dtype=torch.bfloat16) * 0.8)(D, Dh)),
            "wv": _w((lambda *s: torch.randn(*s, dtype=torch.bfloat16) * 0.05)(D, Dh)),
            "wo": _w((lambda *s: torch.randn(*s, dtype=torch.bfloat16) * 0.05)(H * Dh, D)),
        }
    _A_in = _A_setup()

    def _B_setup():
        B, S, D = 1, 2048, 512
        Df = D // 2 + 1
        return {
            "x": _w((lambda *s: torch.randn(*s, dtype=torch.bfloat16) * 0.05)(B, S, D)),
            "w_r": _w((lambda *s: torch.randn(*s, dtype=torch.bfloat16) * 0.4)(S, Df) * 0.02),
            "w_i": _w((lambda *s: torch.randn(*s, dtype=torch.bfloat16) * 0.8)(S, Df) * 0.02),
        }
    _B_in = _B_setup()

    return {
        "A_x": _A_in["x"],
        "A_wq": _A_in["wq"],
        "A_wk": _A_in["wk"],
        "A_wv": _A_in["wv"],
        "A_wo": _A_in["wo"],
        "B_x": _B_in["x"],
        "B_w_r": _B_in["w_r"],
        "B_w_i": _B_in["w_i"],
        "gate_w": _w((lambda *s: torch.randn(*s, dtype=torch.bfloat16) * 0.05)(512) * 16.0),
    }

def reference(A_x, A_wq, A_wk, A_wv, A_wo, B_x, B_w_r, B_w_i, gate_w):
    def _A_ref(x, wq, wk, wv, wo):
        B, S, D = x.shape
        H = 32
        Dh = D // H
        q = (lambda x, *d: x.permute(*d))((x @ wq).reshape(B, S, H, Dh), 0, 2, 1, 3)
        k = x @ wk
        v = x @ wv
        scores = torch.einsum("bhqd,bkd->bhqk", q, k) * (Dh ** -0.5)
        p = _softmax(scores, axis=-1)
        o = torch.einsum("bhqk,bkd->bhqd", p, v)
        return (lambda x, *d: x.permute(*d))(o, 0, 2, 1, 3).reshape(B, S, H * Dh) @ wo

    def _B_ref(x, w_r, w_i):
        B, S, D = x.shape
        X = (lambda x, axes=(-2,-1): torch.fft.rfft2(x.float(), dim=axes))(x, axes=(-2, -1))
        W = w_r + 1j * w_i
        X = X * W
        y = (lambda x, s, axes=(-2,-1): torch.fft.irfft2(x, s=s, dim=axes).to(torch.bfloat16))(X, (S, D), axes=(-2, -1))
        return y

    x = A_x
    g = _sigmoid((x * gate_w).sum(-1, keepdims=True))
    a = _A_ref(x, A_wq, A_wk, A_wv, A_wo)
    b = _B_ref(x, B_w_r, B_w_i)
    return g * a + (1 - g) * b
```

```asm
; @launch kernel=fused_kernel grid=(256,1,1) block=(768,1,1) lds=163344
.amdgcn_target "amdgcn-amd-amdhsa--gfx950"
.text
.globl fused_kernel
.p2align 8
.type fused_kernel,@function
fused_kernel:
    v_lshrrev_b32 v1, 6, v0
    s_cmp_ge_u32 s2, 256
    s_cbranch_scc1 L_exit_2
    v_readfirstlane_b32 s12, v1
    v_and_b32 v0, 63, v0
    v_mov_b32 v30, 0x26400
    s_cmp_lg_u32 s12, 4
    s_cbranch_scc1 L_nz_11
    v_mov_b32 v31, 0
    v_lshl_add_u32 v29, v0, 2, v30
    ds_write_b32 v29, v31
    ds_write_b32 v29, v31 offset:6416
    s_waitcnt lgkmcnt(0)
L_nz_11:
    s_load_dwordx8 s[4:11], s[0:1], 0
    s_load_dwordx4 s[44:47], s[0:1], 80
    s_load_dwordx2 s[32:33], s[0:1], 64
    s_load_dwordx4 s[40:43], s[0:1], 48
    s_cmp_ge_u32 s12, 8
    s_cbranch_scc1 L_pc0_12x
    s_getpc_b64 s[68:69]
L_pc0_12:
    s_and_b32 s14, s2, 24
    s_sub_u32 s68, s68, L_pc0_12-fused_kernel
    s_subb_u32 s69, s69, 0
    s_mov_b32 s70, L_code_end-fused_kernel
    s_mov_b32 s71, 0x00020000
    s_add_u32 s14, s14, s12
    v_lshlrev_b32 v3, 4, v0
    s_lshl_b32 s14, s14, 10
    buffer_load_dwordx4 v[108:111], v3, s[68:71], s14 offen
L_pc0_12x:
    s_barrier
    s_and_b32 s50, s2, 31
    s_lshr_b32 s51, s2, 5
    v_lshrrev_b32 v1, 4, v0
    v_and_b32 v2, 15, v0
    v_lshlrev_b32 v3, 4, v0
    s_lshr_b32 s49, s50, 3
    s_add_u32 s49, s49, s51
    s_and_b32 s49, s49, 3
    s_mov_b32 s19, 0x00020000
    s_mov_b32 s18, 0x200000
    s_mov_b32 s26, 0xd00000
    s_mov_b32 s27, s19
    s_mov_b32 s90, 0x400000
    s_cmp_lt_u32 s12, 8
    s_cbranch_scc1 L_mm_3
    s_cmp_eq_u32 s12, 11
    s_cbranch_scc1 L_misc_5
    s_setprio 3
    s_cmp_lt_u32 s12, 10
    s_cbranch_scc1 L_ld_4
    s_and_b32 s13, s51, 3
    s_and_b32 s14, s51, 1
    s_lshl_b32 s14, s14, 20
    s_lshr_b32 s15, s13, 1
    s_lshl_b32 s36, s50, 1
    s_add_u32 s15, s15, s36
    s_lshl_b32 s15, s15, 10
    s_add_u32 s60, s14, s15
    v_xor_b32 v5, v2, v1
    v_lshlrev_b32 v5, 4, v5
    v_lshl_add_u32 v12, v1, 16, v5
    v_xor_b32 v13, 64, v12
    v_add_u32 v13, 0x3fc00, v13
    v_xor_b32 v14, 128, v12
    v_add_u32 v14, 0x7f800, v14
    v_xor_b32 v15, 192, v12
    v_add_u32 v15, 0xbf400, v15
    s_lshl_b32 s63, s13, 12
    s_movk_i32 s30, 0x4000
    s_mov_b32 s31, s19
    s_movk_i32 s34, 0x400
    s_mov_b32 s35, s19
    s_mov_b32 m0, s63
    s_lshl_b32 s36, s49, 8
    v_add_u32 v6, s36, v3
    s_add_u32 s36, s36, s60
    v_and_b32 v6, 0x3ff, v6
    s_cmp_lt_u32 s51, 4
    s_waitcnt lgkmcnt(0)
    s_cselect_b32 s28, s8, s10
    s_cselect_b32 s29, s9, s11
    s_mov_b32 s16, s4
    s_mov_b32 s17, s5
    buffer_load_dwordx4 v12, s[16:19], s36 offen offset:0 lds
    buffer_load_dwordx4 v13, s[16:19], s36 offen offset:1024 lds
    buffer_load_dwordx4 v14, s[16:19], s36 offen offset:2048 lds
    buffer_load_dwordx4 v15, s[16:19], s36 offen offset:3072 lds
    s_mov_b32 m0, 0x22000
    s_lshl_b32 s36, s49, 12
    buffer_load_dwordx4 v3, s[28:31], s36 offen offset:0 lds
    buffer_load_dwordx4 v3, s[28:31], s36 offen offset:1024 lds
    buffer_load_dwordx4 v3, s[28:31], s36 offen offset:2048 lds
    buffer_load_dwordx4 v3, s[28:31], s36 offen offset:3072 lds
    s_add_u32 s49, s49, 1
    s_and_b32 s49, s49, 3
    s_add_u32 m0, s63, 16384
    s_lshl_b32 s36, s49, 8
    s_add_u32 s36, s36, s60
    buffer_load_dwordx4 v12, s[16:19], s36 offen offset:0 lds
    buffer_load_dwordx4 v13, s[16:19], s36 offen offset:1024 lds
    buffer_load_dwordx4 v14, s[16:19], s36 offen offset:2048 lds
    buffer_load_dwordx4 v15, s[16:19], s36 offen offset:3072 lds
    s_mov_b32 m0, 0x23000
    s_lshl_b32 s36, s49, 12
    buffer_load_dwordx4 v3, s[28:31], s36 offen offset:0 lds
    buffer_load_dwordx4 v3, s[28:31], s36 offen offset:1024 lds
    buffer_load_dwordx4 v3, s[28:31], s36 offen offset:2048 lds
    buffer_load_dwordx4 v3, s[28:31], s36 offen offset:3072 lds
    s_add_u32 s49, s49, 1
    s_and_b32 s49, s49, 3
    s_add_u32 m0, s63, 32768
    s_lshl_b32 s36, s49, 8
    s_add_u32 s36, s36, s60
    buffer_load_dwordx4 v12, s[16:19], s36 offen offset:0 lds
    buffer_load_dwordx4 v13, s[16:19], s36 offen offset:1024 lds
    buffer_load_dwordx4 v14, s[16:19], s36 offen offset:2048 lds
    buffer_load_dwordx4 v15, s[16:19], s36 offen offset:3072 lds
    s_mov_b32 m0, 0x24000
    s_lshl_b32 s36, s49, 12
    buffer_load_dwordx4 v3, s[28:31], s36 offen offset:0 lds
    buffer_load_dwordx4 v3, s[28:31], s36 offen offset:1024 lds
    buffer_load_dwordx4 v3, s[28:31], s36 offen offset:2048 lds
    buffer_load_dwordx4 v3, s[28:31], s36 offen offset:3072 lds
    s_add_u32 s49, s49, 1
    s_and_b32 s49, s49, 3
    s_add_u32 m0, s63, 49152
    s_lshl_b32 s36, s49, 8
    s_add_u32 s36, s36, s60
    buffer_load_dwordx4 v12, s[16:19], s36 offen offset:0 lds
    buffer_load_dwordx4 v13, s[16:19], s36 offen offset:1024 lds
    buffer_load_dwordx4 v14, s[16:19], s36 offen offset:2048 lds
    buffer_load_dwordx4 v15, s[16:19], s36 offen offset:3072 lds
    s_mov_b32 m0, 0x25000
    s_lshl_b32 s36, s49, 12
    buffer_load_dwordx4 v3, s[28:31], s36 offen offset:0 lds
    buffer_load_dwordx4 v3, s[28:31], s36 offen offset:1024 lds
    buffer_load_dwordx4 v3, s[28:31], s36 offen offset:2048 lds
    buffer_load_dwordx4 v3, s[28:31], s36 offen offset:3072 lds
    s_mov_b32 m0, 0x26000
    v_lshl_add_u32 v164, v2, 8, v5
    buffer_load_dwordx4 v6, s[32:35], 0 offen lds
    v_mov_b32 v31, 1
    s_mov_b64 exec, 1
    ds_write_b32 v30, v31 offset:160
    s_mov_b64 exec, -1
    s_mov_b32 s24, s46
    s_mov_b32 s25, s47
    s_mov_b32 s52, 0x23a000
    v_mov_b32 v4, 0
    buffer_load_dword v8, v4, s[24:27], s52 offen sc1
    s_lshl_b32 s53, s50, 3
    s_add_u32 s53, s53, s51
    s_lshl_b32 s53, s53, 5
    s_add_u32 s53, s53, 0x240000
    s_and_b32 s54, s2, 7
    s_lshl_b32 s54, s54, 13
    s_add_u32 s54, s54, 0x240000
    v_lshrrev_b32 v29, 1, v0
    v_lshlrev_b32 v29, 13, v29
    v_and_b32 v15, 1, v0
    v_lshl_add_u32 v29, v15, 4, v29
    v_lshlrev_b32 v162, 5, v0
    v_lshrrev_b32 v5, 2, v2
    v_and_b32 v6, 3, v2
    v_lshl_add_u32 v5, v1, 3, v5
    v_lshlrev_b32 v5, 5, v5
    v_lshl_add_u32 v28, v6, 3, v5
    v_add_u32 v28, 0x22000, v28
    v_lshlrev_b32 v7, 4, v1
    v_add_u32 v7, 0x26000, v7
    s_lshl_b32 s15, s50, 2
    s_add_u32 s15, s15, s13
    v_and_b32 v5, 1, v1
    v_mov_b32 v30, 0x26400
    v_mov_b32 v31, 1
    v_add_u32 v164, s63, v164
    v_mov_b32 v9, 0x27d18
    v_xor_b32 v165, 64, v164
    v_xor_b32 v166, 0x80, v164
    v_xor_b32 v167, 0xc0, v164
    s_sub_u32 s100, s12, 8
    s_lshl_b32 s101, s100, 10
    s_lshl_b32 s100, s100, 4
    v_and_b32 v157, 15, v0
    v_lshrrev_b32 v158, 4, v0
    v_add_u32 v159, s100, v157
    v_lshlrev_b32 v145, 7, v159
    v_lshl_add_u32 v145, v158, 4, v145
    v_mul_u32_u24 v146, 1088, v158
    v_lshl_add_u32 v146, v159, 2, v146
    v_add_u32 v146, 0x22000, v146
    v_mul_u32_u24 v147, 272, v157
    v_lshl_add_u32 v147, v158, 4, v147
    v_add_u32 v147, 0x22000, v147
    v_add_u32 v148, 0x24400, v3
    v_add_u32 v149, s101, v148
    v_lshl_add_u32 v150, v158, 2, s100
    v_lshl_add_u32 v152, v150, 5, v157
    v_mul_u32_u24 v150, 144, v150
    v_lshl_add_u32 v150, v157, 2, v150
    v_add_u32 v150, 0x22000, v150
    v_mul_u32_u24 v151, 144, v159
    v_lshl_add_u32 v151, v158, 4, v151
    v_add_u32 v151, 0x22000, v151
    v_and_b32 v160, 1, v0
    v_lshl_add_u32 v160, v158, 1, v160
    v_lshlrev_b32 v160, 8, v160
    v_lshrrev_b32 v161, 1, v157
    v_lshl_add_u32 v160, v161, 5, v160
    v_lshlrev_b32 v153, 6, v159
    v_lshrrev_b32 v161, 1, v158
    v_lshl_add_u32 v153, v161, 4, v153
    v_and_b32 v161, 1, v158
    v_lshl_add_u32 v153, v161, 5, v153
    v_lshlrev_b32 v154, 5, v0
    v_mov_b32 v155, 0x26400
    v_and_b32 v156, 3, v0
    v_lshl_add_u32 v156, v156, 2, v155
    s_cmp_lt_u32 s51, 4
    s_cbranch_scc0 L_kv_v_13
    s_waitcnt vmcnt(26)
    s_mov_b64 exec, 1
    ds_write2_b32 v9, v31, v31 offset0:0 offset1:4
    s_mov_b64 exec, -1
    ds_read_b128 v[32:35], v164 offset:0
    ds_read_b64_tr_b16 v[96:97], v28 offset:0
    ds_read_b64_tr_b16 v[98:99], v28 offset:128
    ds_read_b128 v[36:39], v165 offset:0
    ds_read_b64_tr_b16 v[100:101], v28 offset:1024
    ds_read_b64_tr_b16 v[102:103], v28 offset:1152
    ds_read_b128 v[40:43], v166 offset:0
    ds_read_b64_tr_b16 v[104:105], v28 offset:2048
    ds_read_b64_tr_b16 v[106:107], v28 offset:2176
    ds_read_b128 v[44:47], v167 offset:0
    ds_read_b64_tr_b16 v[108:109], v28 offset:3072
    ds_read_b64_tr_b16 v[110:111], v28 offset:3200
    s_waitcnt lgkmcnt(9)
    v_mfma_f32_16x16x32_bf16 v[16:19], v[96:99], v[32:35], 0
    s_waitcnt lgkmcnt(6)
    v_mfma_f32_16x16x32_bf16 v[20:23], v[100:103], v[36:39], 0
    s_waitcnt lgkmcnt(3)
    v_mfma_f32_16x16x32_bf16 v[16:19], v[104:107], v[40:43], v[16:19]
    s_waitcnt lgkmcnt(0)
    v_mfma_f32_16x16x32_bf16 v[20:23], v[108:111], v[44:47], v[20:23]
    s_waitcnt vmcnt(18)
    s_mov_b64 exec, 1
    ds_write2_b32 v9, v31, v31 offset0:8 offset1:12
    s_mov_b64 exec, -1
    ds_read_b128 v[48:51], v164 offset:16384
    ds_read_b64_tr_b16 v[112:113], v28 offset:4096
    ds_read_b64_tr_b16 v[114:115], v28 offset:4224
    ds_read_b128 v[52:55], v165 offset:16384
    ds_read_b64_tr_b16 v[116:117], v28 offset:5120
    ds_read_b64_tr_b16 v[118:119], v28 offset:5248
    ds_read_b128 v[56:59], v166 offset:16384
    ds_read_b64_tr_b16 v[120:121], v28 offset:6144
    ds_read_b64_tr_b16 v[122:123], v28 offset:6272
    ds_read_b128 v[60:63], v167 offset:16384
    ds_read_b64_tr_b16 v[124:125], v28 offset:7168
    ds_read_b64_tr_b16 v[126:127], v28 offset:7296
    s_waitcnt lgkmcnt(9)
    v_mfma_f32_16x16x32_bf16 v[16:19], v[112:115], v[48:51], v[16:19]
    s_waitcnt lgkmcnt(6)
    v_mfma_f32_16x16x32_bf16 v[20:23], v[116:119], v[52:55], v[20:23]
    s_waitcnt lgkmcnt(3)
    v_mfma_f32_16x16x32_bf16 v[16:19], v[120:123], v[56:59], v[16:19]
    s_waitcnt lgkmcnt(0)
    v_mfma_f32_16x16x32_bf16 v[20:23], v[124:127], v[60:63], v[20:23]
    s_waitcnt vmcnt(10)
    s_mov_b64 exec, 1
    ds_write2_b32 v9, v31, v31 offset0:16 offset1:20
    s_mov_b64 exec, -1
    ds_read_b128 v[64:67], v164 offset:32768
    ds_read_b64_tr_b16 v[96:97], v28 offset:8192
    ds_read_b64_tr_b16 v[98:99], v28 offset:8320
    ds_read_b128 v[68:71], v165 offset:32768
    ds_read_b64_tr_b16 v[100:101], v28 offset:9216
    ds_read_b64_tr_b16 v[102:103], v28 offset:9344
    ds_read_b128 v[72:75], v166 offset:32768
    ds_read_b64_tr_b16 v[104:105], v28 offset:10240
    ds_read_b64_tr_b16 v[106:107], v28 offset:10368
    ds_read_b128 v[76:79], v167 offset:32768
    ds_read_b64_tr_b16 v[108:109], v28 offset:11264
    ds_read_b64_tr_b16 v[110:111], v28 offset:11392
    s_waitcnt lgkmcnt(9)
    v_mfma_f32_16x16x32_bf16 v[16:19], v[96:99], v[64:67], v[16:19]
    s_waitcnt lgkmcnt(6)
    v_mfma_f32_16x16x32_bf16 v[20:23], v[100:103], v[68:71], v[20:23]
    s_waitcnt lgkmcnt(3)
    v_mfma_f32_16x16x32_bf16 v[16:19], v[104:107], v[72:75], v[16:19]
    s_waitcnt lgkmcnt(0)
    v_mfma_f32_16x16x32_bf16 v[20:23], v[108:111], v[76:79], v[20:23]
    s_waitcnt vmcnt(2)
    s_mov_b64 exec, 1
    ds_write2_b32 v9, v31, v31 offset0:24 offset1:28
    s_mov_b64 exec, -1
    ds_read_b128 v[80:83], v164 offset:49152
    ds_read_b64_tr_b16 v[112:113], v28 offset:12288
    ds_read_b64_tr_b16 v[114:115], v28 offset:12416
    ds_read_b128 v[84:87], v165 offset:49152
    ds_read_b64_tr_b16 v[116:117], v28 offset:13312
    ds_read_b64_tr_b16 v[118:119], v28 offset:13440
    ds_read_b128 v[88:91], v166 offset:49152
    ds_read_b64_tr_b16 v[120:121], v28 offset:14336
    ds_read_b64_tr_b16 v[122:123], v28 offset:14464
    ds_read_b128 v[92:95], v167 offset:49152
    ds_read_b64_tr_b16 v[124:125], v28 offset:15360
    ds_read_b64_tr_b16 v[126:127], v28 offset:15488
    s_waitcnt lgkmcnt(9)
    v_mfma_f32_16x16x32_bf16 v[16:19], v[112:115], v[80:83], v[16:19]
    s_waitcnt lgkmcnt(6)
    v_mfma_f32_16x16x32_bf16 v[20:23], v[116:119], v[84:87], v[20:23]
    s_waitcnt lgkmcnt(3)
    v_mfma_f32_16x16x32_bf16 v[16:19], v[120:123], v[88:91], v[16:19]
    s_waitcnt lgkmcnt(0)
    v_mfma_f32_16x16x32_bf16 v[20:23], v[124:127], v[92:95], v[20:23]
    s_mov_b32 s36, 0x3eb8aa3b
    v_lshlrev_b32 v6, 5, v2
    v_lshl_add_u32 v6, v5, 4, v6
    s_lshl_b32 s37, s15, 9
    s_add_u32 s37, s37, 0x200000
    s_waitcnt vmcnt(0)
    v_add_u32 v8, 0x9e3779b9, v8
    s_mov_b64 exec, 1
    ds_write_b32 v30, v8 offset:6400
    ds_write_b32 v30, v31 offset:12
    s_mov_b64 exec, -1
    s_lshl_b32 s38, s15, 10
    v_mov_b32 v26, v8
    ds_read_b128 v[96:99], v7 offset:0
    ds_read_b128 v[100:103], v7 offset:64
    ds_read_b128 v[104:107], v7 offset:128
    ds_read_b128 v[108:111], v7 offset:192
    v_add_f32 v16, v16, v20
    v_add_f32 v17, v17, v21
    v_add_f32 v18, v18, v22
    v_add_f32 v19, v19, v23
    v_mul_f32 v16, s36, v16
    v_mul_f32 v17, s36, v17
    v_mul_f32 v18, s36, v18
    v_mul_f32 v19, s36, v19
    v_cvt_pk_bf16_f32 v24, v16, v17
    v_cvt_pk_bf16_f32 v25, v18, v19
    s_cmp_ge_u32 s15, 20
    s_cbranch_scc1 L_nt_15
    s_add_u32 s38, s38, 0x780000
    buffer_store_dwordx3 v[24:26], v3, s[24:27], s38 offen sc1
L_nt_15:
    s_nop 0
    v_mov_b32 v26, v24
    v_mov_b32 v27, v25
    s_nop 1
    v_permlane32_swap_b32 v24, v26
    v_permlane32_swap_b32 v25, v27
    s_mov_b32 exec_hi, 0
    buffer_store_dwordx4 v[24:27], v6, s[24:27], s37 offen sc1
    s_mov_b32 exec_hi, -1
    ds_read_b128 v[112:115], v7 offset:256
    ds_read_b128 v[116:119], v7 offset:320
    ds_read_b128 v[120:123], v7 offset:384
    ds_read_b128 v[124:127], v7 offset:448
    s_waitcnt lgkmcnt(4)
    v_mfma_f32_16x16x32_bf16 v[20:23], v[96:99], v[32:35], 0
    v_mfma_f32_16x16x32_bf16 v[20:23], v[100:103], v[36:39], v[20:23]
    v_mfma_f32_16x16x32_bf16 v[20:23], v[104:107], v[40:43], v[20:23]
    v_mfma_f32_16x16x32_bf16 v[20:23], v[108:111], v[44:47], v[20:23]
    s_nop 1
    ds_read_b128 v[96:99], v7 offset:512
    ds_read_b128 v[100:103], v7 offset:576
    ds_read_b128 v[104:107], v7 offset:640
    ds_read_b128 v[108:111], v7 offset:704
    s_waitcnt lgkmcnt(4)
    v_mfma_f32_16x16x32_bf16 v[20:23], v[112:115], v[48:51], v[20:23]
    v_mfma_f32_16x16x32_bf16 v[20:23], v[116:119], v[52:55], v[20:23]
    v_mfma_f32_16x16x32_bf16 v[20:23], v[120:123], v[56:59], v[20:23]
    v_mfma_f32_16x16x32_bf16 v[20:23], v[124:127], v[60:63], v[20:23]
    s_nop 1
    ds_read_b128 v[112:115], v7 offset:768
    ds_read_b128 v[116:119], v7 offset:832
    ds_read_b128 v[120:123], v7 offset:896
    ds_read_b128 v[124:127], v7 offset:960
    s_waitcnt lgkmcnt(4)
    v_mfma_f32_16x16x32_bf16 v[20:23], v[96:99], v[64:67], v[20:23]
    v_mfma_f32_16x16x32_bf16 v[20:23], v[100:103], v[68:71], v[20:23]
    v_mfma_f32_16x16x32_bf16 v[20:23], v[104:107], v[72:75], v[20:23]
    v_mfma_f32_16x16x32_bf16 v[20:23], v[108:111], v[76:79], v[20:23]
    s_nop 1
    s_waitcnt lgkmcnt(0)
    v_mfma_f32_16x16x32_bf16 v[20:23], v[112:115], v[80:83], v[20:23]
    v_mfma_f32_16x16x32_bf16 v[20:23], v[116:119], v[84:87], v[20:23]
    v_mfma_f32_16x16x32_bf16 v[20:23], v[120:123], v[88:91], v[20:23]
    v_mfma_f32_16x16x32_bf16 v[20:23], v[124:127], v[92:95], v[20:23]
    s_lshl_b32 s36, s15, 6
    s_add_u32 s36, s36, 0x220000
    v_lshlrev_b32 v6, 2, v0
    s_nop 4
    v_mul_f32 v26, 0xbfb8aa3b, v20
    v_exp_f32 v26, v26
    s_nop 0
    v_add_f32 v26, 1.0, v26
    v_rcp_f32 v26, v26
    s_mov_b64 exec, 0xffff
    buffer_store_dword v26, v6, s[24:27], s36 offen sc1
    s_branch L_kv_d_14
L_kv_v_13:
    v_and_b32 v12, 1, v0
    v_mul_u32_u24 v27, 288, v12
    v_and_b32 v6, 2, v0
    v_lshl_add_u32 v27, v6, 3, v27
    v_cmp_eq_u32 vcc, 0, v6
    v_mov_b32 v13, 0x3f803f80
    s_mul_i32 s37, s15, 576
    s_add_u32 s37, s37, 0x228000
    v_cndmask_b32 v12, 0, v13, vcc
    v_cndmask_b32 v14, 0, v13, vcc
    v_cndmask_b32 v15, 0, v13, vcc
    v_cndmask_b32 v13, 0, v13, vcc
    v_lshrrev_b32 v5, 1, v1
    v_mul_u32_u24 v6, 288, v5
    v_lshl_add_u32 v6, v2, 4, v6
    s_waitcnt vmcnt(26)
    s_mov_b64 exec, 1
    ds_write2_b32 v9, v31, v31 offset0:0 offset1:4
    s_mov_b64 exec, -1
    ds_read_b128 v[32:35], v164 offset:0
    ds_read_b64_tr_b16 v[96:97], v28 offset:0
    ds_read_b64_tr_b16 v[98:99], v28 offset:128
    ds_read_b128 v[36:39], v165 offset:0
    ds_read_b64_tr_b16 v[100:101], v28 offset:1024
    ds_read_b64_tr_b16 v[102:103], v28 offset:1152
    ds_read_b128 v[40:43], v166 offset:0
    ds_read_b64_tr_b16 v[104:105], v28 offset:2048
    ds_read_b64_tr_b16 v[106:107], v28 offset:2176
    ds_read_b128 v[44:47], v167 offset:0
    ds_read_b64_tr_b16 v[108:109], v28 offset:3072
    ds_read_b64_tr_b16 v[110:111], v28 offset:3200
    s_waitcnt lgkmcnt(9)
    v_mfma_f32_16x16x32_bf16 v[16:19], v[32:35], v[96:99], 0
    s_waitcnt lgkmcnt(6)
    v_mfma_f32_16x16x32_bf16 v[20:23], v[36:39], v[100:103], 0
    s_waitcnt lgkmcnt(3)
    v_mfma_f32_16x16x32_bf16 v[16:19], v[40:43], v[104:107], v[16:19]
    s_waitcnt lgkmcnt(0)
    v_mfma_f32_16x16x32_bf16 v[20:23], v[44:47], v[108:111], v[20:23]
    s_waitcnt vmcnt(18)
    s_mov_b64 exec, 1
    ds_write2_b32 v9, v31, v31 offset0:8 offset1:12
    s_mov_b64 exec, -1
    ds_read_b128 v[48:51], v164 offset:16384
    ds_read_b64_tr_b16 v[112:113], v28 offset:4096
    ds_read_b64_tr_b16 v[114:115], v28 offset:4224
    ds_read_b128 v[52:55], v165 offset:16384
    ds_read_b64_tr_b16 v[116:117], v28 offset:5120
    ds_read_b64_tr_b16 v[118:119], v28 offset:5248
    ds_read_b128 v[56:59], v166 offset:16384
    ds_read_b64_tr_b16 v[120:121], v28 offset:6144
    ds_read_b64_tr_b16 v[122:123], v28 offset:6272
    ds_read_b128 v[60:63], v167 offset:16384
    ds_read_b64_tr_b16 v[124:125], v28 offset:7168
    ds_read_b64_tr_b16 v[126:127], v28 offset:7296
    s_waitcnt lgkmcnt(9)
    v_mfma_f32_16x16x32_bf16 v[16:19], v[48:51], v[112:115], v[16:19]
    s_waitcnt lgkmcnt(6)
    v_mfma_f32_16x16x32_bf16 v[20:23], v[52:55], v[116:119], v[20:23]
    s_waitcnt lgkmcnt(3)
    v_mfma_f32_16x16x32_bf16 v[16:19], v[56:59], v[120:123], v[16:19]
    s_waitcnt lgkmcnt(0)
    v_mfma_f32_16x16x32_bf16 v[20:23], v[60:63], v[124:127], v[20:23]
    s_waitcnt vmcnt(10)
    s_mov_b64 exec, 1
    ds_write2_b32 v9, v31, v31 offset0:16 offset1:20
    s_mov_b64 exec, -1
    ds_read_b128 v[64:67], v164 offset:32768
    ds_read_b64_tr_b16 v[96:97], v28 offset:8192
    ds_read_b64_tr_b16 v[98:99], v28 offset:8320
    ds_read_b128 v[68:71], v165 offset:32768
    ds_read_b64_tr_b16 v[100:101], v28 offset:9216
    ds_read_b64_tr_b16 v[102:103], v28 offset:9344
    ds_read_b128 v[72:75], v166 offset:32768
    ds_read_b64_tr_b16 v[104:105], v28 offset:10240
    ds_read_b64_tr_b16 v[106:107], v28 offset:10368
    ds_read_b128 v[76:79], v167 offset:32768
    ds_read_b64_tr_b16 v[108:109], v28 offset:11264
    ds_read_b64_tr_b16 v[110:111], v28 offset:11392
    s_waitcnt lgkmcnt(9)
    v_mfma_f32_16x16x32_bf16 v[16:19], v[64:67], v[96:99], v[16:19]
    s_waitcnt lgkmcnt(6)
    v_mfma_f32_16x16x32_bf16 v[20:23], v[68:71], v[100:103], v[20:23]
    s_waitcnt lgkmcnt(3)
    v_mfma_f32_16x16x32_bf16 v[16:19], v[72:75], v[104:107], v[16:19]
    s_waitcnt lgkmcnt(0)
    v_mfma_f32_16x16x32_bf16 v[20:23], v[76:79], v[108:111], v[20:23]
    s_waitcnt vmcnt(2)
    s_mov_b64 exec, 1
    ds_write2_b32 v9, v31, v31 offset0:24 offset1:28
    s_mov_b64 exec, -1
    ds_read_b128 v[80:83], v164 offset:49152
    ds_read_b64_tr_b16 v[112:113], v28 offset:12288
    ds_read_b64_tr_b16 v[114:115], v28 offset:12416
    ds_read_b128 v[84:87], v165 offset:49152
    ds_read_b64_tr_b16 v[116:117], v28 offset:13312
    ds_read_b64_tr_b16 v[118:119], v28 offset:13440
    ds_read_b128 v[88:91], v166 offset:49152
    ds_read_b64_tr_b16 v[120:121], v28 offset:14336
    ds_read_b64_tr_b16 v[122:123], v28 offset:14464
    ds_read_b128 v[92:95], v167 offset:49152
    ds_read_b64_tr_b16 v[124:125], v28 offset:15360
    ds_read_b64_tr_b16 v[126:127], v28 offset:15488
    s_waitcnt lgkmcnt(9)
    v_mfma_f32_16x16x32_bf16 v[16:19], v[80:83], v[112:115], v[16:19]
    s_waitcnt lgkmcnt(6)
    v_mfma_f32_16x16x32_bf16 v[20:23], v[84:87], v[116:119], v[20:23]
    s_waitcnt lgkmcnt(3)
    v_mfma_f32_16x16x32_bf16 v[16:19], v[88:91], v[120:123], v[16:19]
    s_waitcnt lgkmcnt(0)
    v_mfma_f32_16x16x32_bf16 v[20:23], v[92:95], v[124:127], v[20:23]
    s_waitcnt vmcnt(0)
    v_add_u32 v8, 0x9e3779b9, v8
    s_mov_b64 exec, 1
    ds_write_b32 v30, v8 offset:6400
    ds_write_b32 v30, v31 offset:12
    s_mov_b64 exec, -1
    s_lshl_b32 s38, s15, 10
    v_mov_b32 v26, v8
    s_mov_b64 exec, 15
    buffer_store_dwordx4 v[12:15], v27, s[24:27], s37 offen offset:256 sc1
    s_mov_b64 exec, -1
    s_nop 4
    v_add_f32 v16, v16, v20
    v_add_f32 v17, v17, v21
    v_add_f32 v18, v18, v22
    v_add_f32 v19, v19, v23
    v_cvt_pk_bf16_f32 v24, v16, v17
    v_cvt_pk_bf16_f32 v25, v18, v19
    s_cmp_ge_u32 s15, 20
    s_cbranch_scc1 L_nt_16
    s_add_u32 s38, s38, 0x788000
    buffer_store_dwordx3 v[24:26], v3, s[24:27], s38 offen sc1
L_nt_16:
    s_nop 0
    v_mov_b32 v26, v24
    v_mov_b32 v27, v25
    s_nop 1
    v_permlane16_swap_b32 v24, v26
    v_permlane16_swap_b32 v25, v27
    s_mov_b32 exec_lo, 0xffff
    s_mov_b32 exec_hi, 0xffff
    buffer_store_dwordx4 v[24:27], v6, s[24:27], s37 offen sc1
    s_waitcnt vmcnt(0)
L_kv_d_14:
    s_waitcnt vmcnt(1)
    s_mov_b64 exec, -1
    v_mov_b32 v9, v8
    v_mov_b32 v10, v8
    v_mov_b32 v11, v8
    s_mov_b64 exec, 65535
    s_add_u32 s36, s53, 0
    buffer_store_dwordx4 v[8:11], v29, s[24:27], s36 offen sc1
    s_mov_b64 exec, -1
    s_mov_b64 exec, 3
    s_branch L_wl_17x
L_wl_17:
    s_sleep 1
    s_sub_u32 s90, s90, 1
    s_cbranch_scc1 L_exit_2
L_wl_17x:
    ds_read_b32 v12, v156 offset:0
    s_waitcnt lgkmcnt(0)
    v_cmp_gt_u32 vcc, 8, v12
    s_cbranch_vccnz L_wl_17
    s_mov_b64 exec, -1
    s_mov_b32 s34, 0
    s_add_u32 s64, s54, 0
    s_mov_b64 s[68:69], -1
    s_add_u32 s65, s54, 2048
    s_mov_b64 s[70:71], -1
    s_add_u32 s66, s54, 4096
    s_mov_b64 s[72:73], -1
    s_add_u32 s67, s54, 6144
    s_mov_b64 s[74:75], -1
L_gp_19:
    s_mov_b64 exec, s[68:69]
    buffer_load_dword v12, v162, s[24:27], s64 offen sc1
    s_mov_b64 exec, s[70:71]
    buffer_load_dword v13, v162, s[24:27], s65 offen sc1
    s_mov_b64 exec, s[72:73]
    buffer_load_dword v14, v162, s[24:27], s66 offen sc1
    s_mov_b64 exec, s[74:75]
    buffer_load_dword v15, v162, s[24:27], s67 offen sc1
    s_add_u32 s34, s34, 1
    s_waitcnt vmcnt(0)
    s_mov_b64 exec, s[68:69]
    v_cmp_ne_u32 s[68:69], v12, v8
    s_mov_b64 exec, s[70:71]
    v_cmp_ne_u32 s[70:71], v13, v8
    s_mov_b64 exec, s[72:73]
    v_cmp_ne_u32 s[72:73], v14, v8
    s_mov_b64 exec, s[74:75]
    v_cmp_ne_u32 s[74:75], v15, v8
    s_nop 0
    s_or_b64 s[76:77], s[68:69], s[70:71]
    s_or_b64 s[76:77], s[76:77], s[72:73]
    s_or_b64 s[76:77], s[76:77], s[74:75]
    s_cbranch_scc0 L_gq_20
    s_sleep 1
    s_cmp_lt_u32 s34, 0x20000
    s_cbranch_scc1 L_gp_19
L_gq_20:
    s_mov_b64 exec, 1
    ds_write_b32 v30, v31 offset:76
    s_mov_b64 exec, -1
L_kw_21:
    s_sleep 8
    s_sub_u32 s90, s90, 1
    s_cbranch_scc1 L_exit_2
    ds_read_b32 v12, v30 offset:64
    s_waitcnt lgkmcnt(0)
    v_readfirstlane_b32 s35, v12
    s_cmp_eq_u32 s35, 1
    s_cbranch_scc0 L_kw_21
    s_mov_b64 exec, 65535
    s_add_u32 s36, s53, 65536
    buffer_store_dwordx4 v[8:11], v29, s[24:27], s36 offen sc1
    s_mov_b64 exec, -1
    s_branch L_ap1_23x
L_ap1_23:
    s_sleep 8
    s_sub_u32 s90, s90, 1
    s_cbranch_scc1 L_exit_2
L_ap1_23x:
    ds_read_b32 v12, v156 offset:192
    s_waitcnt lgkmcnt(0)
    v_cmp_gt_u32 vcc, 1, v12
    s_cbranch_vccnz L_ap1_23
    v_mov_b32 v24, 100
    s_mov_b32 s34, 0
    s_add_u32 s64, s54, 65536
    s_mov_b64 s[68:69], -1
    s_add_u32 s65, s54, 67584
    s_mov_b64 s[70:71], -1
    s_add_u32 s66, s54, 69632
    s_mov_b64 s[72:73], -1
    s_add_u32 s67, s54, 71680
    s_mov_b64 s[74:75], -1
L_gp_24:
    s_mov_b64 exec, s[68:69]
    buffer_load_dword v12, v162, s[24:27], s64 offen sc1
    s_mov_b64 exec, s[70:71]
    buffer_load_dword v13, v162, s[24:27], s65 offen sc1
    s_mov_b64 exec, s[72:73]
    buffer_load_dword v14, v162, s[24:27], s66 offen sc1
    s_mov_b64 exec, s[74:75]
    buffer_load_dword v15, v162, s[24:27], s67 offen sc1
    s_add_u32 s34, s34, 1
    s_waitcnt vmcnt(0)
    s_mov_b64 exec, s[68:69]
    v_cmp_ne_u32 s[68:69], v12, v8
    s_mov_b64 exec, s[70:71]
    v_cmp_ne_u32 s[70:71], v13, v8
    s_mov_b64 exec, s[72:73]
    v_cmp_ne_u32 s[72:73], v14, v8
    s_mov_b64 exec, s[74:75]
    v_cmp_ne_u32 s[74:75], v15, v8
    s_nop 0
    s_or_b64 s[76:77], s[68:69], s[70:71]
    s_or_b64 s[76:77], s[76:77], s[72:73]
    s_or_b64 s[76:77], s[76:77], s[74:75]
    s_cbranch_scc0 L_gq_25
    s_sleep 2
    s_cmp_lt_u32 s34, 0x20000
    s_cbranch_scc1 L_gp_24
L_gq_25:
    s_mov_b64 exec, 1
    ds_write_b32 v30, v24 offset:8
    s_mov_b64 exec, -1
    v_readfirstlane_b32 s55, v8
    s_cmp_lg_u32 s2, 0
    s_cbranch_scc1 L_fft_6x
    s_mov_b64 exec, 1
    buffer_store_dword v8, v4, s[24:27], s52 offen sc1
    s_mov_b64 exec, -1
    s_branch L_fft_6x
L_ld_4:
    s_sub_u32 s13, s12, 8
    v_xor_b32 v5, v2, v1
    v_lshlrev_b32 v5, 4, v5
    v_lshl_add_u32 v8, v1, 16, v5
    v_xor_b32 v9, 64, v8
    v_add_u32 v9, 0x3fc00, v9
    v_xor_b32 v10, 128, v8
    v_add_u32 v10, 0x7f800, v10
    v_xor_b32 v11, 192, v8
    v_add_u32 v11, 0xbf400, v11
    s_lshl_b32 s14, s13, 7
    s_lshl_b32 s15, s13, 19
    v_xor_b32 v18, s14, v8
    v_xor_b32 v19, s14, v9
    v_add_u32 v18, s15, v18
    v_add_u32 v19, s15, v19
    s_lshl_b32 s14, s13, 1
    s_add_u32 s14, s14, 1
    s_xor_b32 s14, s14, s51
    s_and_b32 s14, s14, 3
    s_xor_b32 s15, s51, 2
    s_and_b32 s15, s15, 3
    s_lshl_b32 s63, s14, 12
    s_lshl_b32 s58, s15, 12
    s_lshl_b32 s36, s13, 11
    s_add_u32 s58, s58, s36
    s_lshl_b32 s36, s50, 11
    s_and_b32 s37, s14, 1
    s_lshl_b32 s37, s37, 20
    s_lshr_b32 s14, s14, 1
    s_lshl_b32 s14, s14, 10
    s_add_u32 s60, s36, s37
    s_add_u32 s60, s60, s14
    s_and_b32 s37, s15, 1
    s_lshl_b32 s37, s37, 20
    s_lshr_b32 s15, s15, 1
    s_lshl_b32 s15, s15, 10
    s_add_u32 s59, s36, s37
    s_add_u32 s59, s59, s15
    s_mov_b32 s48, s49
    v_lshrrev_b32 v5, 3, v0
    v_lshlrev_b32 v5, 10, v5
    v_and_b32 v6, 7, v0
    v_and_b32 v7, 1, v1
    v_lshlrev_b32 v7, 2, v7
    v_xor_b32 v6, v6, v7
    v_lshl_add_u32 v12, v6, 4, v5
    v_add_u32 v13, 0x1c00, v12
    v_add_u32 v14, 0x3800, v12
    v_add_u32 v15, 0x5400, v12
    s_lshl_b32 s61, s13, 15
    s_lshl_b32 s14, s51, 7
    s_add_u32 s61, s61, s14
    s_lshl_b32 s62, s13, 12
    s_add_u32 s62, s62, 0x10000
    s_mov_b32 s22, 0x80000
    s_mov_b32 s23, s19
    v_mov_b32 v16, 7
    s_getpc_b64 s[68:69]
L_pc2_26:
    s_mov_b32 s70, 64
    s_mov_b32 s71, s19
    s_lshl_b32 s64, s13, 2
    s_add_u32 s64, s64, 0x27d10
    v_mov_b32 v17, 0x26400
    v_lshl_add_u32 v17, s13, 2, v17
    s_waitcnt lgkmcnt(0)
    s_mov_b32 s16, s4
    s_mov_b32 s17, s5
    s_mov_b32 s20, s6
    s_mov_b32 s21, s7
    s_sub_u32 s100, s12, 8
    s_lshl_b32 s101, s100, 10
    s_lshl_b32 s100, s100, 4
    v_and_b32 v157, 15, v0
    v_lshrrev_b32 v158, 4, v0
    v_add_u32 v159, s100, v157
    v_lshlrev_b32 v145, 7, v159
    v_lshl_add_u32 v145, v158, 4, v145
    v_mul_u32_u24 v146, 1088, v158
    v_lshl_add_u32 v146, v159, 2, v146
    v_add_u32 v146, 0x22000, v146
    v_mul_u32_u24 v147, 272, v157
    v_lshl_add_u32 v147, v158, 4, v147
    v_add_u32 v147, 0x22000, v147
    v_add_u32 v148, 0x24400, v3
    v_add_u32 v149, s101, v148
    v_lshl_add_u32 v150, v158, 2, s100
    v_lshl_add_u32 v152, v150, 5, v157
    v_mul_u32_u24 v150, 144, v150
    v_lshl_add_u32 v150, v157, 2, v150
    v_add_u32 v150, 0x22000, v150
    v_mul_u32_u24 v151, 144, v159
    v_lshl_add_u32 v151, v158, 4, v151
    v_add_u32 v151, 0x22000, v151
    v_and_b32 v160, 1, v0
    v_lshl_add_u32 v160, v158, 1, v160
    v_lshlrev_b32 v160, 8, v160
    v_lshrrev_b32 v161, 1, v157
    v_lshl_add_u32 v160, v161, 5, v160
    v_lshlrev_b32 v153, 6, v159
    v_lshrrev_b32 v161, 1, v158
    v_lshl_add_u32 v153, v161, 4, v153
    v_and_b32 v161, 1, v158
    v_lshl_add_u32 v153, v161, 5, v153
    v_lshlrev_b32 v154, 5, v0
    v_mov_b32 v155, 0x26400
    v_and_b32 v156, 3, v0
    v_lshl_add_u32 v156, v156, 2, v155
L_kvf_27:
    s_sub_u32 s90, s90, 1
    s_cbranch_scc1 L_exit_2
    ds_read_b32 v5, v30 offset:160
    s_waitcnt lgkmcnt(0)
    v_readfirstlane_b32 s35, v5
    s_cmp_eq_u32 s35, 1
    s_cbranch_scc0 L_kvf_27
    s_add_u32 m0, s63, 0
    s_lshl_b32 s37, s49, 8
    s_add_u32 s36, s37, s60
    buffer_load_dwordx4 v8, s[16:19], s36 offen offset:0 lds
    buffer_load_dwordx4 v9, s[16:19], s36 offen offset:1024 lds
    buffer_load_dwordx4 v10, s[16:19], s36 offen offset:2048 lds
    buffer_load_dwordx4 v11, s[16:19], s36 offen offset:3072 lds
    s_add_u32 m0, s58, 0
    s_add_u32 s36, s37, s59
    buffer_load_dwordx4 v18, s[16:19], s36 offen offset:0 lds
    buffer_load_dwordx4 v19, s[16:19], s36 offen offset:1024 lds
    s_add_u32 s49, s49, 1
    s_and_b32 s49, s49, 3
    s_add_u32 m0, s64, 0
    s_mov_b64 exec, 1
    buffer_load_dword off, s[68:71], 0 lds
    s_mov_b64 exec, -1
    s_add_u32 m0, s62, 0
    s_lshl_b32 s37, s48, 17
    s_add_u32 s37, s37, s61
    buffer_load_dwordx4 v12, s[20:23], s37 offen offset:0 lds
    buffer_load_dwordx4 v13, s[20:23], s37 offen offset:1024 lds
    buffer_load_dwordx4 v14, s[20:23], s37 offen offset:2048 lds
    buffer_load_dwordx4 v15, s[20:23], s37 offen offset:3072 lds
    s_add_u32 m0, s62, 8192
    s_add_u32 s37, s37, 0x10000
    buffer_load_dwordx4 v12, s[20:23], s37 offen offset:0 lds
    buffer_load_dwordx4 v13, s[20:23], s37 offen offset:1024 lds
    buffer_load_dwordx4 v14, s[20:23], s37 offen offset:2048 lds
    buffer_load_dwordx4 v15, s[20:23], s37 offen offset:3072 lds
    s_add_u32 s48, s48, 1
    s_and_b32 s48, s48, 3
    s_add_u32 m0, s64, 16
    s_mov_b64 exec, 1
    buffer_load_dword off, s[68:71], 0 lds
    s_mov_b64 exec, -1
    s_add_u32 m0, s63, 16384
    s_lshl_b32 s37, s49, 8
    s_add_u32 s36, s37, s60
    buffer_load_dwordx4 v8, s[16:19], s36 offen offset:0 lds
    buffer_load_dwordx4 v9, s[16:19], s36 offen offset:1024 lds
    buffer_load_dwordx4 v10, s[16:19], s36 offen offset:2048 lds
    buffer_load_dwordx4 v11, s[16:19], s36 offen offset:3072 lds
    s_add_u32 m0, s58, 16384
    s_add_u32 s36, s37, s59
    buffer_load_dwordx4 v18, s[16:19], s36 offen offset:0 lds
    buffer_load_dwordx4 v19, s[16:19], s36 offen offset:1024 lds
    s_add_u32 s49, s49, 1
    s_and_b32 s49, s49, 3
    s_add_u32 m0, s64, 32
    s_mov_b64 exec, 1
    buffer_load_dword off, s[68:71], 0 lds
    s_mov_b64 exec, -1
    s_add_u32 m0, s62, 16384
    s_lshl_b32 s37, s48, 17
    s_add_u32 s37, s37, s61
    buffer_load_dwordx4 v12, s[20:23], s37 offen offset:0 lds
    s_waitcnt vmcnt(23)
    buffer_load_dwordx4 v13, s[20:23], s37 offen offset:1024 lds
    s_waitcnt vmcnt(23)
    buffer_load_dwordx4 v14, s[20:23], s37 offen offset:2048 lds
    s_waitcnt vmcnt(23)
    buffer_load_dwordx4 v15, s[20:23], s37 offen offset:3072 lds
    s_add_u32 m0, s62, 24576
    s_add_u32 s37, s37, 0x10000
    s_waitcnt vmcnt(23)
    buffer_load_dwordx4 v12, s[20:23], s37 offen offset:0 lds
    s_waitcnt vmcnt(23)
    buffer_load_dwordx4 v13, s[20:23], s37 offen offset:1024 lds
    s_waitcnt vmcnt(23)
    buffer_load_dwordx4 v14, s[20:23], s37 offen offset:2048 lds
    s_waitcnt vmcnt(23)
    s_waitcnt vmcnt(23)
    buffer_load_dwordx4 v15, s[20:23], s37 offen offset:3072 lds
    s_add_u32 s48, s48, 1
    s_and_b32 s48, s48, 3
    s_waitcnt vmcnt(23)
    s_add_u32 m0, s64, 48
    s_mov_b64 exec, 1
    buffer_load_dword off, s[68:71], 0 lds
    s_mov_b64 exec, -1
    s_add_u32 m0, s63, 32768
    s_lshl_b32 s37, s49, 8
    s_add_u32 s36, s37, s60
    s_waitcnt vmcnt(23)
    buffer_load_dwordx4 v8, s[16:19], s36 offen offset:0 lds
    s_waitcnt vmcnt(23)
    buffer_load_dwordx4 v9, s[16:19], s36 offen offset:1024 lds
    s_waitcnt vmcnt(23)
    buffer_load_dwordx4 v10, s[16:19], s36 offen offset:2048 lds
    s_waitcnt vmcnt(23)
    buffer_load_dwordx4 v11, s[16:19], s36 offen offset:3072 lds
    s_add_u32 m0, s58, 32768
    s_add_u32 s36, s37, s59
    s_waitcnt vmcnt(23)
    buffer_load_dwordx4 v18, s[16:19], s36 offen offset:0 lds
    s_waitcnt vmcnt(23)
    buffer_load_dwordx4 v19, s[16:19], s36 offen offset:1024 lds
    s_add_u32 s49, s49, 1
    s_and_b32 s49, s49, 3
    s_waitcnt vmcnt(23)
    s_add_u32 m0, s64, 64
    s_mov_b64 exec, 1
    buffer_load_dword off, s[68:71], 0 lds
    s_mov_b64 exec, -1
    s_add_u32 m0, s62, 32768
    s_lshl_b32 s37, s48, 17
    s_add_u32 s37, s37, s61
    s_waitcnt vmcnt(23)
    s_waitcnt vmcnt(23)
    buffer_load_dwordx4 v12, s[20:23], s37 offen offset:0 lds
    s_waitcnt vmcnt(23)
    buffer_load_dwordx4 v13, s[20:23], s37 offen offset:1024 lds
    s_waitcnt vmcnt(23)
    buffer_load_dwordx4 v14, s[20:23], s37 offen offset:2048 lds
    s_waitcnt vmcnt(23)
    buffer_load_dwordx4 v15, s[20:23], s37 offen offset:3072 lds
    s_add_u32 m0, s62, 40960
    s_add_u32 s37, s37, 0x10000
    s_waitcnt vmcnt(23)
    buffer_load_dwordx4 v12, s[20:23], s37 offen offset:0 lds
    s_waitcnt vmcnt(23)
    buffer_load_dwordx4 v13, s[20:23], s37 offen offset:1024 lds
    s_waitcnt vmcnt(23)
    buffer_load_dwordx4 v14, s[20:23], s37 offen offset:2048 lds
    s_waitcnt vmcnt(23)
    s_waitcnt vmcnt(23)
    buffer_load_dwordx4 v15, s[20:23], s37 offen offset:3072 lds
    s_add_u32 s48, s48, 1
    s_and_b32 s48, s48, 3
    s_waitcnt vmcnt(23)
    s_add_u32 m0, s64, 80
    s_mov_b64 exec, 1
    buffer_load_dword off, s[68:71], 0 lds
    s_mov_b64 exec, -1
    s_add_u32 m0, s63, 49152
    s_lshl_b32 s37, s49, 8
    s_add_u32 s36, s37, s60
    s_waitcnt vmcnt(23)
    buffer_load_dwordx4 v8, s[16:19], s36 offen offset:0 lds
    s_waitcnt vmcnt(23)
    buffer_load_dwordx4 v9, s[16:19], s36 offen offset:1024 lds
    s_waitcnt vmcnt(23)
    buffer_load_dwordx4 v10, s[16:19], s36 offen offset:2048 lds
    s_waitcnt vmcnt(23)
    buffer_load_dwordx4 v11, s[16:19], s36 offen offset:3072 lds
    s_add_u32 m0, s58, 49152
    s_add_u32 s36, s37, s59
    s_waitcnt vmcnt(23)
    buffer_load_dwordx4 v18, s[16:19], s36 offen offset:0 lds
    s_waitcnt vmcnt(23)
    buffer_load_dwordx4 v19, s[16:19], s36 offen offset:1024 lds
    s_add_u32 s49, s49, 1
    s_and_b32 s49, s49, 3
    s_waitcnt vmcnt(23)
    s_add_u32 m0, s64, 96
    s_mov_b64 exec, 1
    buffer_load_dword off, s[68:71], 0 lds
    s_mov_b64 exec, -1
    s_add_u32 m0, s62, 49152
    s_lshl_b32 s37, s48, 17
    s_add_u32 s37, s37, s61
    s_waitcnt vmcnt(23)
    s_waitcnt vmcnt(23)
    buffer_load_dwordx4 v12, s[20:23], s37 offen offset:0 lds
    s_waitcnt vmcnt(23)
    buffer_load_dwordx4 v13, s[20:23], s37 offen offset:1024 lds
    s_waitcnt vmcnt(23)
    buffer_load_dwordx4 v14, s[20:23], s37 offen offset:2048 lds
    s_waitcnt vmcnt(23)
    buffer_load_dwordx4 v15, s[20:23], s37 offen offset:3072 lds
    s_add_u32 m0, s62, 57344
    s_add_u32 s37, s37, 0x10000
    s_waitcnt vmcnt(23)
    buffer_load_dwordx4 v12, s[20:23], s37 offen offset:0 lds
    s_waitcnt vmcnt(23)
    buffer_load_dwordx4 v13, s[20:23], s37 offen offset:1024 lds
    s_waitcnt vmcnt(23)
    buffer_load_dwordx4 v14, s[20:23], s37 offen offset:2048 lds
    s_waitcnt vmcnt(23)
    s_waitcnt vmcnt(23)
    buffer_load_dwordx4 v15, s[20:23], s37 offen offset:3072 lds
    s_add_u32 s48, s48, 1
    s_and_b32 s48, s48, 3
    s_waitcnt vmcnt(23)
    s_add_u32 m0, s64, 112
    s_mov_b64 exec, 1
    buffer_load_dword off, s[68:71], 0 lds
    s_mov_b64 exec, -1
    s_mov_b32 s24, s46
    s_mov_b32 s25, s47
    s_lshl_b32 s15, s13, 10
    s_add_u32 s39, s15, 0x780000
    v_mov_b32 v11, 0x26400
    v_and_b32 v6, 31, v0
    v_lshrrev_b32 v7, 5, v0
    v_lshlrev_b32 v6, 5, v6
    v_lshl_add_u32 v6, v7, 4, v6
    s_lshl_b32 s15, s13, 10
    s_add_u32 s20, s15, 0x200000
    s_add_u32 s21, s15, 0x228000
    s_add_u32 s22, s15, 0x10000
    v_and_b32 v5, 1, v1
    v_lshrrev_b32 v7, 1, v1
    v_lshlrev_b32 v24, 4, v2
    v_lshl_add_u32 v25, v5, 3, v24
    v_lshl_add_u32 v24, v5, 9, v24
    v_lshl_add_u32 v24, v7, 3, v24
    v_lshl_add_u32 v24, s13, 8, v24
    s_mul_i32 s14, s13, 576
    s_add_u32 s14, s14, 0x10000
    v_mul_u32_u24 v7, 288, v7
    v_add3_u32 v25, v25, v7, s14
    v_lshrrev_b32 v5, 2, v0
    v_mul_u32_u24 v5, 1152, v5
    v_bfe_u32 v7, v0, 1, 1
    v_mul_u32_u24 v7, 288, v7
    v_add3_u32 v26, v5, v7, s14
    v_and_b32 v5, 1, v0
    v_cmp_eq_u32 vcc, 0, v5
    v_lshl_add_u32 v26, v5, 4, v26
    v_mov_b32 v5, 0x3f803f80
    v_cndmask_b32 v120, 0, v5, vcc
    v_cndmask_b32 v121, 0, v5, vcc
    v_cndmask_b32 v122, 0, v5, vcc
    v_cndmask_b32 v123, 0, v5, vcc
    s_waitcnt vmcnt(16)
    s_waitcnt vmcnt(13)
    s_add_u32 s40, s39, 0x0
    buffer_load_dwordx3 v[32:34], v3, s[24:27], s40 offen offset:0 sc1
    s_waitcnt vmcnt(13)
    s_add_u32 s41, s39, 0x8000
    buffer_load_dwordx3 v[36:38], v3, s[24:27], s41 offen offset:0 sc1
    s_waitcnt vmcnt(13)
    buffer_load_dwordx3 v[40:42], v3, s[24:27], s40 offen offset:2048 sc1
    s_waitcnt vmcnt(13)
    buffer_load_dwordx3 v[44:46], v3, s[24:27], s41 offen offset:2048 sc1
    s_waitcnt vmcnt(13)
    s_waitcnt vmcnt(13)
    s_add_u32 s40, s39, 0x1000
    buffer_load_dwordx3 v[48:50], v3, s[24:27], s40 offen offset:0 sc1
    s_waitcnt vmcnt(13)
    s_add_u32 s41, s39, 0x9000
    buffer_load_dwordx3 v[52:54], v3, s[24:27], s41 offen offset:0 sc1
    s_waitcnt vmcnt(13)
    buffer_load_dwordx3 v[56:58], v3, s[24:27], s40 offen offset:2048 sc1
    s_waitcnt vmcnt(13)
    buffer_load_dwordx3 v[60:62], v3, s[24:27], s41 offen offset:2048 sc1
    s_waitcnt vmcnt(13)
    s_add_u32 s40, s39, 0x2000
    buffer_load_dwordx3 v[64:66], v3, s[24:27], s40 offen offset:0 sc1
    s_waitcnt vmcnt(13)
    s_add_u32 s41, s39, 0xa000
    buffer_load_dwordx3 v[68:70], v3, s[24:27], s41 offen offset:0 sc1
    s_waitcnt vmcnt(13)
    buffer_load_dwordx3 v[72:74], v3, s[24:27], s40 offen offset:2048 sc1
    s_waitcnt vmcnt(13)
    buffer_load_dwordx3 v[76:78], v3, s[24:27], s41 offen offset:2048 sc1
    s_waitcnt vmcnt(13)
    s_add_u32 s40, s39, 0x3000
    buffer_load_dwordx3 v[80:82], v3, s[24:27], s40 offen offset:0 sc1
    s_waitcnt vmcnt(13)
    v_add_u32 v16, 1, v16
    s_mov_b64 exec, 1
    ds_write_b32 v17, v16
    s_mov_b64 exec, -1
    s_add_u32 s41, s39, 0xb000
    buffer_load_dwordx3 v[84:86], v3, s[24:27], s41 offen offset:0 sc1
    buffer_load_dwordx3 v[88:90], v3, s[24:27], s40 offen offset:2048 sc1
    buffer_load_dwordx3 v[92:94], v3, s[24:27], s41 offen offset:2048 sc1
    s_add_u32 s40, s39, 0x4000
    buffer_load_dwordx3 v[96:98], v3, s[24:27], s40 offen offset:0 sc1
    s_add_u32 s41, s39, 0xc000
    buffer_load_dwordx3 v[100:102], v3, s[24:27], s41 offen offset:0 sc1
    buffer_load_dwordx3 v[104:106], v3, s[24:27], s40 offen offset:2048 sc1
    buffer_load_dwordx3 v[108:110], v3, s[24:27], s41 offen offset:2048 sc1
    s_branch L_pw_28x
L_pw_28:
    s_sub_u32 s90, s90, 1
    s_cbranch_scc1 L_exit_2
L_pw_28x:
    ds_read_b32 v5, v11 offset:12
    ds_read_b32 v12, v156 offset:16
    ds_read_b32 v13, v156 offset:32
    ds_read_b32 v27, v11 offset:6400
    s_waitcnt lgkmcnt(0)
    v_cmp_eq_u32 vcc, 0, v5
    s_cbranch_vccnz L_pw_28
    v_min_u32 v12, v12, v13
    v_cmp_gt_u32 vcc, 1, v12
    s_cbranch_vccnz L_pw_28
    s_mov_b32 exec_hi, 0xff
    ds_write_b128 v26, v[120:123] offset:256
    s_mov_b32 exec_hi, -1
L_tg_29:
    s_waitcnt vmcnt(19)
    ds_write_b64 v24, v[32:33] offset:0
    v_xor_b32 v28, v27, v34
    s_waitcnt vmcnt(18)
    ds_write_b64 v25, v[36:37] offset:0
    v_xor_b32 v39, v27, v38
    s_waitcnt vmcnt(17)
    ds_write_b64 v24, v[40:41] offset:1024
    v_xor_b32 v43, v27, v42
    v_or3_b32 v28, v28, v43, v39
    s_waitcnt vmcnt(16)
    ds_write_b64 v25, v[44:45] offset:1152
    v_xor_b32 v47, v27, v46
    s_waitcnt vmcnt(15)
    ds_write_b64 v24, v[48:49] offset:2048
    v_xor_b32 v51, v27, v50
    v_or3_b32 v28, v28, v51, v47
    s_waitcnt vmcnt(14)
    ds_write_b64 v25, v[52:53] offset:2304
    v_xor_b32 v55, v27, v54
    s_waitcnt vmcnt(13)
    ds_write_b64 v24, v[56:57] offset:3072
    v_xor_b32 v59, v27, v58
    v_or3_b32 v28, v28, v59, v55
    s_waitcnt vmcnt(12)
    ds_write_b64 v25, v[60:61] offset:3456
    v_xor_b32 v63, v27, v62
    v_or_b32 v28, v28, v63
    v_cmp_ne_u32 vcc, 0, v28
    s_cbranch_vccz L_th_30
    s_sub_u32 s90, s90, 64
    s_cbranch_scc1 L_exit_2
    s_waitcnt lgkmcnt(0)
    s_add_u32 s40, s39, 0x0
    buffer_load_dwordx3 v[32:34], v3, s[24:27], s40 offen offset:0 sc1
    s_add_u32 s41, s39, 0x8000
    buffer_load_dwordx3 v[36:38], v3, s[24:27], s41 offen offset:0 sc1
    buffer_load_dwordx3 v[40:42], v3, s[24:27], s40 offen offset:2048 sc1
    buffer_load_dwordx3 v[44:46], v3, s[24:27], s41 offen offset:2048 sc1
    s_add_u32 s40, s39, 0x1000
    buffer_load_dwordx3 v[48:50], v3, s[24:27], s40 offen offset:0 sc1
    s_add_u32 s41, s39, 0x9000
    buffer_load_dwordx3 v[52:54], v3, s[24:27], s41 offen offset:0 sc1
    buffer_load_dwordx3 v[56:58], v3, s[24:27], s40 offen offset:2048 sc1
    buffer_load_dwordx3 v[60:62], v3, s[24:27], s41 offen offset:2048 sc1
    s_waitcnt vmcnt(0)
    s_branch L_tg_29
L_th_30:
    v_add_u32 v16, 1, v16
    s_mov_b64 exec, 1
    ds_write_b32 v17, v16
    s_mov_b64 exec, -1
L_tg_31:
    s_waitcnt vmcnt(11)
    ds_write_b64 v24, v[64:65] offset:4096
    v_xor_b32 v28, v27, v66
    s_waitcnt vmcnt(10)
    ds_write_b64 v25, v[68:69] offset:4608
    v_xor_b32 v71, v27, v70
    s_waitcnt vmcnt(9)
    ds_write_b64 v24, v[72:73] offset:5120
    v_xor_b32 v75, v27, v74
    v_or3_b32 v28, v28, v75, v71
    s_waitcnt vmcnt(8)
    ds_write_b64 v25, v[76:77] offset:5760
    v_xor_b32 v79, v27, v78
    s_waitcnt vmcnt(7)
    ds_write_b64 v24, v[80:81] offset:6144
    v_xor_b32 v83, v27, v82
    v_or3_b32 v28, v28, v83, v79
    s_waitcnt vmcnt(6)
    ds_write_b64 v25, v[84:85] offset:6912
    v_xor_b32 v87, v27, v86
    s_waitcnt vmcnt(5)
    ds_write_b64 v24, v[88:89] offset:7168
    v_xor_b32 v91, v27, v90
    v_or3_b32 v28, v28, v91, v87
    s_waitcnt vmcnt(4)
    ds_write_b64 v25, v[92:93] offset:8064
    v_xor_b32 v95, v27, v94
    s_waitcnt vmcnt(3)
    ds_write_b64 v24, v[96:97] offset:8192
    v_xor_b32 v99, v27, v98
    v_or3_b32 v28, v28, v99, v95
    s_waitcnt vmcnt(2)
    ds_write_b64 v25, v[100:101] offset:9216
    v_xor_b32 v103, v27, v102
    s_waitcnt vmcnt(1)
    ds_write_b64 v24, v[104:105] offset:9216
    v_xor_b32 v107, v27, v106
    v_or3_b32 v28, v28, v107, v103
    s_waitcnt vmcnt(0)
    ds_write_b64 v25, v[108:109] offset:10368
    v_xor_b32 v111, v27, v110
    v_or_b32 v28, v28, v111
    v_cmp_ne_u32 vcc, 0, v28
    s_cbranch_vccz L_th_32
    s_sub_u32 s90, s90, 64
    s_cbranch_scc1 L_exit_2
    s_waitcnt lgkmcnt(0)
    s_add_u32 s40, s39, 0x2000
    buffer_load_dwordx3 v[64:66], v3, s[24:27], s40 offen offset:0 sc1
    s_add_u32 s41, s39, 0xa000
    buffer_load_dwordx3 v[68:70], v3, s[24:27], s41 offen offset:0 sc1
    buffer_load_dwordx3 v[72:74], v3, s[24:27], s40 offen offset:2048 sc1
    buffer_load_dwordx3 v[76:78], v3, s[24:27], s41 offen offset:2048 sc1
    s_add_u32 s40, s39, 0x3000
    buffer_load_dwordx3 v[80:82], v3, s[24:27], s40 offen offset:0 sc1
    s_add_u32 s41, s39, 0xb000
    buffer_load_dwordx3 v[84:86], v3, s[24:27], s41 offen offset:0 sc1
    buffer_load_dwordx3 v[88:90], v3, s[24:27], s40 offen offset:2048 sc1
    buffer_load_dwordx3 v[92:94], v3, s[24:27], s41 offen offset:2048 sc1
    s_add_u32 s40, s39, 0x4000
    buffer_load_dwordx3 v[96:98], v3, s[24:27], s40 offen offset:0 sc1
    s_add_u32 s41, s39, 0xc000
    buffer_load_dwordx3 v[100:102], v3, s[24:27], s41 offen offset:0 sc1
    buffer_load_dwordx3 v[104:106], v3, s[24:27], s40 offen offset:2048 sc1
    buffer_load_dwordx3 v[108:110], v3, s[24:27], s41 offen offset:2048 sc1
    s_waitcnt vmcnt(0)
    s_branch L_tg_31
L_th_32:
    v_add_u32 v16, 1, v16
    s_mov_b64 exec, 1
    ds_write_b32 v17, v16
    s_mov_b64 exec, -1
    s_branch L_pw_33x
L_pw_33:
    s_sleep 1
    s_sub_u32 s90, s90, 1
    s_cbranch_scc1 L_exit_2
L_pw_33x:
    ds_read_b32 v5, v11 offset:76
    ds_read_b32 v12, v156 offset:16
    ds_read_b32 v13, v156 offset:32
    s_waitcnt lgkmcnt(0)
    v_cmp_eq_u32 vcc, 0, v5
    s_cbranch_vccnz L_pw_33
    v_min_u32 v12, v12, v13
    v_cmp_gt_u32 vcc, 4, v12
    s_cbranch_vccnz L_pw_33
    s_add_u32 m0, s15, 10240
    s_add_u32 s36, s20, 10240
    buffer_load_dwordx4 v6, s[24:27], s36 offen sc1 lds
    s_add_u32 m0, s22, 10240
    s_add_u32 s36, s21, 10240
    buffer_load_dwordx4 v3, s[24:27], s36 offen sc1 lds
    s_add_u32 m0, s15, 12288
    s_add_u32 s36, s20, 12288
    buffer_load_dwordx4 v6, s[24:27], s36 offen sc1 lds
    s_add_u32 m0, s22, 12288
    s_add_u32 s36, s21, 12288
    buffer_load_dwordx4 v3, s[24:27], s36 offen sc1 lds
    s_add_u32 m0, s15, 14336
    s_add_u32 s36, s20, 14336
    buffer_load_dwordx4 v6, s[24:27], s36 offen sc1 lds
    s_add_u32 m0, s22, 14336
    s_add_u32 s36, s21, 14336
    buffer_load_dwordx4 v3, s[24:27], s36 offen sc1 lds
    s_add_u32 m0, s15, 16384
    s_add_u32 s36, s20, 16384
    buffer_load_dwordx4 v6, s[24:27], s36 offen sc1 lds
    s_add_u32 m0, s22, 16384
    s_add_u32 s36, s21, 16384
    buffer_load_dwordx4 v3, s[24:27], s36 offen sc1 lds
    s_add_u32 m0, s22, 18432
    s_add_u32 s36, s21, 18432
    buffer_load_dwordx4 v3, s[24:27], s36 offen sc1 lds
    s_add_u32 m0, s22, 20480
    s_add_u32 s36, s21, 20480
    buffer_load_dwordx4 v3, s[24:27], s36 offen sc1 lds
    s_add_u32 m0, s15, 18432
    s_add_u32 s36, s20, 18432
    buffer_load_dwordx4 v6, s[24:27], s36 offen sc1 lds
    s_add_u32 m0, s22, 22528
    s_add_u32 s36, s21, 22528
    buffer_load_dwordx4 v3, s[24:27], s36 offen sc1 lds
    s_add_u32 m0, s15, 20480
    s_add_u32 s36, s20, 20480
    buffer_load_dwordx4 v6, s[24:27], s36 offen sc1 lds
    s_add_u32 m0, s22, 24576
    s_add_u32 s36, s21, 24576
    buffer_load_dwordx4 v3, s[24:27], s36 offen sc1 lds
    s_add_u32 m0, s15, 22528
    s_add_u32 s36, s20, 22528
    buffer_load_dwordx4 v6, s[24:27], s36 offen sc1 lds
    s_add_u32 m0, s22, 26624
    s_add_u32 s36, s21, 26624
    buffer_load_dwordx4 v3, s[24:27], s36 offen sc1 lds
    s_add_u32 m0, s15, 24576
    s_add_u32 s36, s20, 24576
    buffer_load_dwordx4 v6, s[24:27], s36 offen sc1 lds
    s_add_u32 m0, s22, 28672
    s_add_u32 s36, s21, 28672
    buffer_load_dwordx4 v3, s[24:27], s36 offen sc1 lds
    s_waitcnt vmcnt(8)
    v_add_u32 v16, 1, v16
    s_mov_b64 exec, 1
    ds_write_b32 v17, v16
    s_mov_b64 exec, -1
    s_add_u32 m0, s15, 26624
    s_add_u32 s36, s20, 26624
    buffer_load_dwordx4 v6, s[24:27], s36 offen sc1 lds
    s_add_u32 m0, s22, 30720
    s_add_u32 s36, s21, 30720
    buffer_load_dwordx4 v3, s[24:27], s36 offen sc1 lds
    s_add_u32 m0, s15, 28672
    s_add_u32 s36, s20, 28672
    buffer_load_dwordx4 v6, s[24:27], s36 offen sc1 lds
    s_add_u32 m0, s22, 32768
    s_add_u32 s36, s21, 32768
    buffer_load_dwordx4 v3, s[24:27], s36 offen sc1 lds
    s_add_u32 m0, s15, 30720
    s_add_u32 s36, s20, 30720
    buffer_load_dwordx4 v6, s[24:27], s36 offen sc1 lds
    s_add_u32 m0, s22, 34816
    s_add_u32 s36, s21, 34816
    buffer_load_dwordx4 v3, s[24:27], s36 offen sc1 lds
    s_add_u32 m0, s15, 32768
    s_add_u32 s36, s20, 32768
    buffer_load_dwordx4 v6, s[24:27], s36 offen sc1 lds
    s_add_u32 m0, s22, 36864
    s_add_u32 s36, s21, 36864
    buffer_load_dwordx4 v3, s[24:27], s36 offen sc1 lds
    s_add_u32 m0, s22, 38912
    s_add_u32 s36, s21, 38912
    buffer_load_dwordx4 v3, s[24:27], s36 offen sc1 lds
    s_waitcnt vmcnt(9)
    v_add_u32 v16, 1, v16
    s_mov_b64 exec, 1
    ds_write_b32 v17, v16
    s_mov_b64 exec, -1
    s_add_u32 m0, s15, 34816
    s_add_u32 s36, s20, 34816
    buffer_load_dwordx4 v6, s[24:27], s36 offen sc1 lds
    s_add_u32 m0, s22, 40960
    s_add_u32 s36, s21, 40960
    buffer_load_dwordx4 v3, s[24:27], s36 offen sc1 lds
    s_add_u32 m0, s15, 36864
    s_add_u32 s36, s20, 36864
    buffer_load_dwordx4 v6, s[24:27], s36 offen sc1 lds
    s_add_u32 m0, s22, 43008
    s_add_u32 s36, s21, 43008
    buffer_load_dwordx4 v3, s[24:27], s36 offen sc1 lds
    s_add_u32 m0, s15, 38912
    s_add_u32 s36, s20, 38912
    buffer_load_dwordx4 v6, s[24:27], s36 offen sc1 lds
    s_add_u32 m0, s22, 45056
    s_add_u32 s36, s21, 45056
    buffer_load_dwordx4 v3, s[24:27], s36 offen sc1 lds
    s_add_u32 m0, s15, 40960
    s_add_u32 s36, s20, 40960
    buffer_load_dwordx4 v6, s[24:27], s36 offen sc1 lds
    s_add_u32 m0, s22, 47104
    s_add_u32 s36, s21, 47104
    buffer_load_dwordx4 v3, s[24:27], s36 offen sc1 lds
    s_waitcnt vmcnt(8)
    v_add_u32 v16, 1, v16
    s_mov_b64 exec, 1
    ds_write_b32 v17, v16
    s_mov_b64 exec, -1
    s_add_u32 m0, s15, 43008
    s_add_u32 s36, s20, 43008
    buffer_load_dwordx4 v6, s[24:27], s36 offen sc1 lds
    s_add_u32 m0, s22, 49152
    s_add_u32 s36, s21, 49152
    buffer_load_dwordx4 v3, s[24:27], s36 offen sc1 lds
    s_add_u32 m0, s15, 45056
    s_add_u32 s36, s20, 45056
    buffer_load_dwordx4 v6, s[24:27], s36 offen sc1 lds
    s_add_u32 m0, s22, 51200
    s_add_u32 s36, s21, 51200
    buffer_load_dwordx4 v3, s[24:27], s36 offen sc1 lds
    s_add_u32 m0, s15, 47104
    s_add_u32 s36, s20, 47104
    buffer_load_dwordx4 v6, s[24:27], s36 offen sc1 lds
    s_add_u32 m0, s22, 53248
    s_add_u32 s36, s21, 53248
    buffer_load_dwordx4 v3, s[24:27], s36 offen sc1 lds
    s_add_u32 m0, s15, 49152
    s_add_u32 s36, s20, 49152
    buffer_load_dwordx4 v6, s[24:27], s36 offen sc1 lds
    s_add_u32 m0, s22, 55296
    s_add_u32 s36, s21, 55296
    buffer_load_dwordx4 v3, s[24:27], s36 offen sc1 lds
    s_add_u32 m0, s22, 57344
    s_add_u32 s36, s21, 57344
    buffer_load_dwordx4 v3, s[24:27], s36 offen sc1 lds
    s_waitcnt vmcnt(9)
    v_add_u32 v16, 1, v16
    s_mov_b64 exec, 1
    ds_write_b32 v17, v16
    s_mov_b64 exec, -1
    s_branch L_fxw_34x
L_fxw_34:
    s_sleep 2
    s_sub_u32 s90, s90, 1
    s_cbranch_scc1 L_exit_2
L_fxw_34x:
    ds_read_b32 v5, v11 offset:68
    s_waitcnt lgkmcnt(0)
    v_readfirstlane_b32 s35, v5
    s_cmp_eq_u32 s35, 1
    s_cbranch_scc0 L_fxw_34
    s_add_u32 m0, s15, 51200
    s_add_u32 s36, s20, 51200
    buffer_load_dwordx4 v6, s[24:27], s36 offen sc1 lds
    s_add_u32 m0, s22, 59392
    s_add_u32 s36, s21, 59392
    buffer_load_dwordx4 v3, s[24:27], s36 offen sc1 lds
    s_add_u32 m0, s15, 53248
    s_add_u32 s36, s20, 53248
    buffer_load_dwordx4 v6, s[24:27], s36 offen sc1 lds
    s_add_u32 m0, s22, 61440
    s_add_u32 s36, s21, 61440
    buffer_load_dwordx4 v3, s[24:27], s36 offen sc1 lds
    s_add_u32 m0, s15, 55296
    s_add_u32 s36, s20, 55296
    buffer_load_dwordx4 v6, s[24:27], s36 offen sc1 lds
    s_add_u32 m0, s22, 63488
    s_add_u32 s36, s21, 63488
    buffer_load_dwordx4 v3, s[24:27], s36 offen sc1 lds
    s_add_u32 m0, s15, 57344
    s_add_u32 s36, s20, 57344
    buffer_load_dwordx4 v6, s[24:27], s36 offen sc1 lds
    s_add_u32 m0, s22, 65536
    s_add_u32 s36, s21, 65536
    buffer_load_dwordx4 v3, s[24:27], s36 offen sc1 lds
    s_waitcnt vmcnt(8)
    v_add_u32 v16, 1, v16
    s_mov_b64 exec, 1
    ds_write_b32 v17, v16
    s_mov_b64 exec, -1
    s_add_u32 m0, s15, 59392
    s_add_u32 s36, s20, 59392
    buffer_load_dwordx4 v6, s[24:27], s36 offen sc1 lds
    s_add_u32 m0, s22, 67584
    s_add_u32 s36, s21, 67584
    buffer_load_dwordx4 v3, s[24:27], s36 offen sc1 lds
    s_add_u32 m0, s15, 61440
    s_add_u32 s36, s20, 61440
    buffer_load_dwordx4 v6, s[24:27], s36 offen sc1 lds
    s_add_u32 m0, s22, 69632
    s_add_u32 s36, s21, 69632
    buffer_load_dwordx4 v3, s[24:27], s36 offen sc1 lds
    s_add_u32 m0, s15, 63488
    s_add_u32 s36, s20, 63488
    buffer_load_dwordx4 v6, s[24:27], s36 offen sc1 lds
    s_add_u32 m0, s22, 71680
    s_add_u32 s36, s21, 71680
    buffer_load_dwordx4 v3, s[24:27], s36 offen sc1 lds
    s_waitcnt vmcnt(6)
    v_add_u32 v16, 1, v16
    s_mov_b64 exec, 1
    ds_write_b32 v17, v16
    s_mov_b64 exec, -1
    s_waitcnt vmcnt(0)
    v_add_u32 v16, 1, v16
    s_mov_b64 exec, 1
    ds_write_b32 v17, v16
    s_mov_b64 exec, -1
    s_branch L_fft_6x
L_misc_5:
    s_load_dwordx2 s[80:81], s[0:1], 32
    s_mov_b32 s74, 0x101000
    s_mov_b32 s75, s19
    s_mov_b32 s78, 0x101000
    s_mov_b32 s79, s19
    s_bfe_u32 s36, s2, 0x10005
    s_lshl_b32 s36, s36, 4
    s_lshr_b32 s14, s2, 6
    s_lshl_b32 s14, s14, 9
    s_add_u32 s36, s36, s14
    s_and_b32 s14, s2, 1
    s_lshl_b32 s14, s14, 3
    s_add_u32 s36, s36, s14
    s_bfe_u32 s14, s2, 0x20001
    s_lshl_b32 s14, s14, 7
    s_add_u32 s36, s36, s14
    s_bfe_u32 s14, s2, 0x20003
    s_lshl_b32 s14, s14, 5
    s_add_u32 s36, s36, s14
    v_bfe_u32 v5, v0, 2, 3
    v_add_u32 v16, s36, v5
    v_sub_u32 v17, 0x800, v16
    v_and_b32 v17, 0x7ff, v17
    v_and_b32 v5, 1, v0
    v_cmp_eq_u32 vcc, 1, v5
    v_and_b32 v6, 2, v0
    v_lshlrev_b32 v6, 8, v6
    v_cndmask_b32 v16, v16, v17, vcc
    s_movk_i32 s14, 514
    v_mad_u32_u24 v16, v16, s14, v6
    s_lshl_b32 s85, s2, 7
    s_add_u32 s85, s85, 0x708000
    s_waitcnt lgkmcnt(0)
    s_mov_b32 s72, s40
    s_mov_b32 s73, s41
    s_mov_b32 s76, s42
    s_mov_b32 s77, s43
    buffer_load_ushort v18, v16, s[72:75], 0 offen
    buffer_load_ushort v19, v16, s[76:79], 0 offen
    s_mov_b32 s24, s46
    s_mov_b32 s25, s47
    s_mov_b32 s82, 0x80000
    s_mov_b32 s83, s19
    v_lshrrev_b32 v5, 2, v0
    v_and_b32 v6, 3, v0
    v_lshlrev_b32 v5, 10, v5
    v_lshl_add_u32 v5, v6, 4, v5
    s_and_b32 s14, s2, 15
    s_lshl_b32 s14, s14, 15
    s_lshr_b32 s15, s2, 4
    s_lshl_b32 s15, s15, 6
    s_mov_b32 m0, 0x27500
    s_add_u32 s14, s14, s15
    buffer_load_dwordx4 v5, s[80:83], s14 offen lds
    s_mov_b32 m0, 0x27900
    s_add_u32 s14, s14, 0x4000
    buffer_load_dwordx4 v5, s[80:83], s14 offen lds
    v_bfe_u32 v5, v0, 3, 1
    v_lshrrev_b32 v6, 4, v0
    v_lshlrev_b32 v6, 1, v6
    v_lshl_add_u32 v5, v5, 4, v6
    v_and_b32 v6, 7, v0
    v_lshlrev_b32 v6, 4, v6
    s_movk_i32 s14, 514
    v_mad_u32_u24 v4, v5, s14, v6
    s_lshr_b32 s14, s2, 4
    s_lshl_b32 s14, s14, 7
    s_bfe_u32 s15, s2, 0x10002
    s_lshl_b32 s15, s15, 3
    s_add_u32 s14, s14, s15
    s_bfe_u32 s37, s2, 0x10003
    s_add_u32 s14, s14, s37
    s_mul_i32 s14, s14, 514
    s_and_b32 s15, s2, 3
    s_lshl_b32 s15, s15, 6
    s_add_u32 s15, s15, s37
    s_lshl_b32 s36, s15, 1
    s_add_u32 s64, s14, s36
    s_add_u32 s65, s64, 16448
    s_add_u32 s66, s64, 32896
    s_add_u32 s67, s64, 49344
    s_lshl_b32 s15, s15, 13
    s_lshr_b32 s14, s2, 2
    s_lshl_b32 s14, s14, 7
    s_add_u32 s15, s15, s14
    s_add_u32 s84, s15, 0x500000
    s_mov_b32 s13, s2
    s_cmp_ge_u32 s13, 56
    s_cbranch_scc1 L_md_38
    s_cmp_ge_u32 s13, 40
    s_cbranch_scc1 L_tw_35
    s_cmp_ge_u32 s13, 32
    s_cbranch_scc1 L_t32_36
    s_lshr_b32 s14, s13, 3
    s_lshr_b32 s15, s13, 2
    s_and_b32 s15, s15, 1
    s_and_b32 s36, s13, 3
    s_mov_b32 s37, 0x3c800000
    s_lshl_b32 s56, s13, 10
    s_add_u32 s56, s56, 0x712000
    s_branch L_tgo_37
L_t32_36:
    s_sub_u32 s13, s13, 32
    s_lshr_b32 s14, s13, 2
    s_lshr_b32 s15, s13, 1
    s_and_b32 s15, s15, 1
    s_and_b32 s36, s13, 1
    s_mov_b32 s37, 0x3d000000
    s_lshl_b32 s56, s13, 10
    s_add_u32 s56, s56, 0x710000
L_tgo_37:
    s_lshl_b32 s14, s14, 4
    v_add_u32 v5, s14, v2
    s_lshl_b32 s36, s36, 4
    v_lshl_add_u32 v6, v1, 2, s36
    v_cvt_f32_u32 v5, v5
    v_mul_f32 v5, s37, v5
    v_cvt_f32_u32 v6, v6
    v_mul_f32 v7, v5, v6
    s_cmp_eq_u32 s15, 0
    s_cselect_b32 s39, 0, 0x3e800000
    s_cselect_b32 s48, 0xbe800000, 0
    v_add_f32 v14, s39, v7
    v_add_f32 v15, s48, v7
    v_cos_f32 v32, v14
    v_cos_f32 v33, v15
    v_add_f32 v7, v7, v5
    v_add_f32 v14, s39, v7
    v_add_f32 v15, s48, v7
    v_cos_f32 v34, v14
    v_cos_f32 v35, v15
    v_add_f32 v7, v7, v5
    v_add_f32 v14, s39, v7
    v_add_f32 v15, s48, v7
    v_cos_f32 v36, v14
    v_cos_f32 v37, v15
    v_add_f32 v7, v7, v5
    v_add_f32 v14, s39, v7
    v_add_f32 v15, s48, v7
    v_cos_f32 v38, v14
    v_cos_f32 v39, v15
    v_add_f32 v7, v7, v5
    v_cvt_pk_bf16_f32 v20, v32, v33
    v_cvt_pk_bf16_f32 v21, v34, v35
    v_cvt_pk_bf16_f32 v22, v36, v37
    v_cvt_pk_bf16_f32 v23, v38, v39
    buffer_store_dwordx4 v[20:23], v3, s[24:27], s56 offen sc1
    s_branch L_md_38
L_tw_35:
    s_sub_u32 s13, s13, 40
    s_and_b32 s14, s13, 1
    s_lshl_b32 s14, s14, 4
    s_lshr_b32 s15, s13, 1
    s_and_b32 s15, s15, 3
    s_lshl_b32 s15, s15, 4
    s_cmp_ge_u32 s13, 8
    s_cselect_b32 s36, s14, s15
    s_cselect_b32 s37, s15, s14
    s_cselect_b32 s39, 0x36000000, 1.0
    v_add_u32 v5, s36, v2
    v_lshl_add_u32 v6, v1, 2, s37
    v_cvt_f32_u32 v5, v5
    v_mul_f32 v5, 0x3a000000, v5
    v_cvt_f32_u32 v6, v6
    v_mul_f32 v7, v5, v6
    v_cos_f32 v20, v7
    v_sin_f32 v24, v7
    v_add_f32 v7, v7, v5
    v_cos_f32 v21, v7
    v_sin_f32 v25, v7
    v_add_f32 v7, v7, v5
    v_cos_f32 v22, v7
    v_sin_f32 v26, v7
    v_add_f32 v7, v7, v5
    v_cos_f32 v23, v7
    v_sin_f32 v27, v7
    v_add_f32 v7, v7, v5
    v_cvt_pk_f16_f32 v20, v20, v24
    v_cvt_pk_f16_f32 v21, v21, v25
    v_cvt_pk_f16_f32 v22, v22, v26
    v_cvt_pk_f16_f32 v23, v23, v27
    s_lshl_b32 s56, s13, 10
    s_add_u32 s56, s56, 0x71a000
    buffer_store_dwordx4 v[20:23], v3, s[24:27], s56 offen sc1
L_md_38:
    s_nop 1
    v_lshlrev_b32 v23, 31, v0
    v_lshlrev_b32 v24, 30, v0
    v_and_b32 v24, 0x80000000, v24
    v_lshlrev_b32 v5, 2, v0
    v_mov_b32 v11, 0x26400
    v_mov_b32 v8, 1
    s_waitcnt vmcnt(0)
    v_lshlrev_b32 v18, 16, v18
    v_lshlrev_b32 v19, 16, v19
    v_xor_b32 v19, v19, v23
    s_nop 0
    v_add_f32_dpp v18, v18, v18 quad_perm:[1,0,3,2] row_mask:0xf bank_mask:0xf
    v_add_f32_dpp v19, v19, v19 quad_perm:[1,0,3,2] row_mask:0xf bank_mask:0xf
    s_nop 0
    v_cndmask_b32 v18, v18, v19, vcc
    s_nop 0
    v_xor_b32 v19, v18, v24
    s_nop 0
    v_add_f32_dpp v18, v18, v19 quad_perm:[2,3,0,1] row_mask:0xf bank_mask:0xf
    v_mul_f32 v18, 0x3e000000, v18
    s_mov_b32 exec_hi, 0
    buffer_store_dword v18, v5, s[24:27], s85 offen sc1
    s_mov_b64 exec, -1
    v_and_b32 v12, 1, v1
    v_lshrrev_b32 v13, 2, v2
    v_and_b32 v14, 3, v2
    v_lshrrev_b32 v15, 5, v0
    v_lshl_add_u32 v13, v15, 2, v13
    v_lshlrev_b32 v13, 6, v13
    v_lshl_add_u32 v13, v12, 5, v13
    v_lshl_add_u32 v13, v14, 3, v13
    v_add_u32 v13, 0x27500, v13
    ds_read_b64_tr_b16 v[64:65], v13
    ds_read_b64_tr_b16 v[66:67], v13 offset:512
    ds_read_b64_tr_b16 v[68:69], v13 offset:1024
    ds_read_b64_tr_b16 v[70:71], v13 offset:1536
    v_mov_b32 v72, -1
    v_mov_b32 v73, -1
    v_mov_b32 v74, -1
    v_mov_b32 v75, -1
    s_lshl_b32 s38, s2, 11
    s_add_u32 s38, s38, 0xc00000
    s_lshl_b32 s39, s50, 16
    s_lshl_b32 s37, s51, 12
    s_add_u32 s39, s39, s37
    s_add_u32 s39, s39, 0x800000
    v_add_u32 v9, 0x20000, v3
    v_lshlrev_b32 v10, 13, v1
    v_lshl_add_u32 v10, v2, 4, v10
    s_lshl_b32 s36, s51, 18
    s_lshl_b32 s37, s50, 8
    s_add_u32 s36, s36, s37
    s_add_u32 s36, s36, 0x300000
    v_lshrrev_b32 v12, 3, v0
    v_and_b32 v13, 7, v0
    v_lshlrev_b32 v12, 16, v12
    v_lshl_add_u32 v7, v13, 4, v12
    s_sub_u32 s100, s12, 8
    s_lshl_b32 s101, s100, 10
    s_lshl_b32 s100, s100, 4
    v_and_b32 v157, 15, v0
    v_lshrrev_b32 v158, 4, v0
    v_add_u32 v159, s100, v157
    v_lshlrev_b32 v145, 7, v159
    v_lshl_add_u32 v145, v158, 4, v145
    v_mul_u32_u24 v146, 1088, v158
    v_lshl_add_u32 v146, v159, 2, v146
    v_add_u32 v146, 0x22000, v146
    v_mul_u32_u24 v147, 272, v157
    v_lshl_add_u32 v147, v158, 4, v147
    v_add_u32 v147, 0x22000, v147
    v_add_u32 v148, 0x24400, v3
    v_add_u32 v149, s101, v148
    v_lshl_add_u32 v150, v158, 2, s100
    v_lshl_add_u32 v152, v150, 5, v157
    v_mul_u32_u24 v150, 144, v150
    v_lshl_add_u32 v150, v157, 2, v150
    v_add_u32 v150, 0x22000, v150
    v_mul_u32_u24 v151, 144, v159
    v_lshl_add_u32 v151, v158, 4, v151
    v_add_u32 v151, 0x22000, v151
    v_and_b32 v160, 1, v0
    v_lshl_add_u32 v160, v158, 1, v160
    v_lshlrev_b32 v160, 8, v160
    v_lshrrev_b32 v161, 1, v157
    v_lshl_add_u32 v160, v161, 5, v160
    v_lshlrev_b32 v153, 6, v159
    v_lshrrev_b32 v161, 1, v158
    v_lshl_add_u32 v153, v161, 4, v153
    v_and_b32 v161, 1, v158
    v_lshl_add_u32 v153, v161, 5, v153
    v_lshlrev_b32 v154, 5, v0
    v_mov_b32 v155, 0x26400
    v_and_b32 v156, 3, v0
    v_lshl_add_u32 v156, v156, 2, v155
    v_and_b32 v12, 7, v0
    v_lshrrev_b32 v13, 3, v0
    v_add_u32 v14, v12, v13
    v_and_b32 v14, 7, v14
    v_lshlrev_b32 v14, 4, v14
    v_add_u32 v14, 0x20000, v14
    v_lshl_add_u32 v5, v12, 7, v14
    v_lshl_add_u32 v6, v13, 7, v14
    s_mov_b32 s14, 0x05040100
    s_mov_b32 s15, 0x07060302
    v_lshrrev_b32 v16, 1, v0
    v_lshlrev_b32 v16, 13, v16
    v_and_b32 v17, 1, v0
    v_lshl_add_u32 v16, v17, 4, v16
    s_setprio 3
L_mw_39:
    s_sleep 1
    s_sub_u32 s90, s90, 1
    s_cbranch_scc1 L_exit_2
    ds_read_b32 v12, v156 offset:48
    s_waitcnt lgkmcnt(0)
    v_cmp_eq_u32 vcc, 0, v12
    s_cbranch_vccnz L_mw_39
    ds_read_b128 v[32:35], v9 offset:0
    ds_read_b128 v[36:39], v9 offset:1024
    ds_read_b128 v[40:43], v9 offset:2048
    ds_read_b128 v[44:47], v9 offset:3072
    ds_read_b128 v[48:51], v9 offset:4096
    ds_read_b128 v[52:55], v9 offset:5120
    ds_read_b128 v[56:59], v9 offset:6144
    ds_read_b128 v[60:63], v9 offset:7168
    s_waitcnt lgkmcnt(0)
    s_mov_b64 exec, 3
    s_branch L_wl_40x
L_wl_40:
    s_sleep 1
    s_sub_u32 s90, s90, 1
    s_cbranch_scc1 L_exit_2
L_wl_40x:
    ds_read_b32 v12, v156 offset:0
    s_waitcnt lgkmcnt(0)
    v_cmp_gt_u32 vcc, 9, v12
    s_cbranch_vccnz L_wl_40
    s_mov_b64 exec, -1
    buffer_store_dwordx4 v[32:35], v10, s[24:27], s36 offen sc1
    s_add_u32 s36, s36, 0x8000
    buffer_store_dwordx4 v[36:39], v10, s[24:27], s36 offen sc1
    s_add_u32 s36, s36, 0x8000
    buffer_store_dwordx4 v[40:43], v10, s[24:27], s36 offen sc1
    s_add_u32 s36, s36, 0x8000
    buffer_store_dwordx4 v[44:47], v10, s[24:27], s36 offen sc1
    s_add_u32 s36, s36, 0x8000
    buffer_store_dwordx4 v[48:51], v10, s[24:27], s36 offen sc1
    s_add_u32 s36, s36, 0x8000
    buffer_store_dwordx4 v[52:55], v10, s[24:27], s36 offen sc1
    s_add_u32 s36, s36, 0x8000
    buffer_store_dwordx4 v[56:59], v10, s[24:27], s36 offen sc1
    s_add_u32 s36, s36, 0x8000
    buffer_store_dwordx4 v[60:63], v10, s[24:27], s36 offen sc1
    buffer_load_dwordx4 v[80:83], v4, s[72:75], s64 offen
    buffer_load_dwordx4 v[96:99], v4, s[76:79], s64 offen
    buffer_load_dwordx4 v[84:87], v4, s[72:75], s65 offen
    buffer_load_dwordx4 v[100:103], v4, s[76:79], s65 offen
    buffer_load_dwordx4 v[88:91], v4, s[72:75], s66 offen
    buffer_load_dwordx4 v[104:107], v4, s[76:79], s66 offen
    buffer_load_dwordx4 v[92:95], v4, s[72:75], s67 offen
    buffer_load_dwordx4 v[108:111], v4, s[76:79], s67 offen
    ds_read_b32 v12, v11 offset:6400
    ds_read_b32 v13, v11 offset:6400
    ds_read_b32 v14, v11 offset:6400
    ds_read_b32 v15, v11 offset:6400
    s_lshl_b32 s36, s2, 5
    s_add_u32 s36, s36, 0x740000
    s_waitcnt vmcnt(8)
    s_mov_b64 exec, 1
    ds_write_b32 v11, v8 offset:64
    s_mov_b64 exec, -1
    s_waitcnt lgkmcnt(0)
    buffer_store_dwordx4 v[64:67], v3, s[24:27], s38 offen sc1
    buffer_store_dwordx4 v[68:71], v3, s[24:27], s38 offen offset:1024 sc1
    buffer_store_dwordx4 v[72:75], v3, s[24:27], s39 offen offset:0 sc1
    buffer_store_dwordx4 v[72:75], v3, s[24:27], s39 offen offset:1024 sc1
    buffer_store_dwordx4 v[72:75], v3, s[24:27], s39 offen offset:2048 sc1
    buffer_store_dwordx4 v[72:75], v3, s[24:27], s39 offen offset:3072 sc1
    s_add_u32 s39, s39, 0x8000
    buffer_store_dwordx4 v[72:75], v3, s[24:27], s39 offen offset:0 sc1
    buffer_store_dwordx4 v[72:75], v3, s[24:27], s39 offen offset:1024 sc1
    buffer_store_dwordx4 v[72:75], v3, s[24:27], s39 offen offset:2048 sc1
    buffer_store_dwordx4 v[72:75], v3, s[24:27], s39 offen offset:3072 sc1
    s_waitcnt lgkmcnt(0)
    s_waitcnt vmcnt(10)
    v_perm_b32 v112, v96, v80, s14
    v_perm_b32 v113, v100, v84, s14
    v_perm_b32 v114, v104, v88, s14
    v_perm_b32 v115, v108, v92, s14
    ds_write_b128 v5, v[112:115] offset:0
    v_perm_b32 v116, v96, v80, s15
    v_perm_b32 v117, v100, v84, s15
    v_perm_b32 v118, v104, v88, s15
    v_perm_b32 v119, v108, v92, s15
    ds_write_b128 v5, v[116:119] offset:1024
    v_perm_b32 v120, v97, v81, s14
    v_perm_b32 v121, v101, v85, s14
    v_perm_b32 v122, v105, v89, s14
    v_perm_b32 v123, v109, v93, s14
    ds_write_b128 v5, v[120:123] offset:2048
    v_perm_b32 v124, v97, v81, s15
    v_perm_b32 v125, v101, v85, s15
    v_perm_b32 v126, v105, v89, s15
    v_perm_b32 v127, v109, v93, s15
    ds_write_b128 v5, v[124:127] offset:3072
    v_perm_b32 v128, v98, v82, s14
    v_perm_b32 v129, v102, v86, s14
    v_perm_b32 v130, v106, v90, s14
    v_perm_b32 v131, v110, v94, s14
    ds_write_b128 v5, v[128:131] offset:4096
    v_perm_b32 v132, v98, v82, s15
    v_perm_b32 v133, v102, v86, s15
    v_perm_b32 v134, v106, v90, s15
    v_perm_b32 v135, v110, v94, s15
    ds_write_b128 v5, v[132:135] offset:5120
    v_perm_b32 v136, v99, v83, s14
    v_perm_b32 v137, v103, v87, s14
    v_perm_b32 v138, v107, v91, s14
    v_perm_b32 v139, v111, v95, s14
    ds_write_b128 v5, v[136:139] offset:6144
    v_perm_b32 v140, v99, v83, s15
    v_perm_b32 v141, v103, v87, s15
    v_perm_b32 v142, v107, v91, s15
    v_perm_b32 v143, v111, v95, s15
    ds_write_b128 v5, v[140:143] offset:7168
    s_waitcnt lgkmcnt(6)
    ds_read_b128 v[112:115], v6 offset:0
    ds_read_b128 v[116:119], v6 offset:1024
    ds_read_b128 v[120:123], v6 offset:2048
    ds_read_b128 v[124:127], v6 offset:3072
    ds_read_b128 v[128:131], v6 offset:4096
    ds_read_b128 v[132:135], v6 offset:5120
    ds_read_b128 v[136:139], v6 offset:6144
    ds_read_b128 v[140:143], v6 offset:7168
    s_waitcnt lgkmcnt(7)
    buffer_store_dwordx4 v[112:115], v7, s[24:27], s84 offen sc1
    s_add_u32 s84, s84, 0x2000
    s_waitcnt lgkmcnt(6)
    buffer_store_dwordx4 v[116:119], v7, s[24:27], s84 offen sc1
    s_add_u32 s84, s84, 0x2000
    s_waitcnt lgkmcnt(5)
    buffer_store_dwordx4 v[120:123], v7, s[24:27], s84 offen sc1
    s_add_u32 s84, s84, 0x2000
    s_waitcnt lgkmcnt(4)
    buffer_store_dwordx4 v[124:127], v7, s[24:27], s84 offen sc1
    s_add_u32 s84, s84, 0x2000
    s_waitcnt lgkmcnt(3)
    buffer_store_dwordx4 v[128:131], v7, s[24:27], s84 offen sc1
    s_add_u32 s84, s84, 0x2000
    s_waitcnt lgkmcnt(2)
    buffer_store_dwordx4 v[132:135], v7, s[24:27], s84 offen sc1
    s_add_u32 s84, s84, 0x2000
    s_waitcnt lgkmcnt(1)
    buffer_store_dwordx4 v[136:139], v7, s[24:27], s84 offen sc1
    s_add_u32 s84, s84, 0x2000
    s_waitcnt lgkmcnt(0)
    buffer_store_dwordx4 v[140:143], v7, s[24:27], s84 offen sc1
    s_mov_b64 exec, 1
    ds_write_b32 v11, v8 offset:68
    s_mov_b64 exec, -1
    s_mov_b64 exec, 65535
    s_waitcnt vmcnt(0)
    buffer_store_dwordx4 v[12:15], v16, s[24:27], s36 offen sc1
    s_mov_b64 exec, -1
    s_branch L_fft_6x
L_mm_3:
    s_and_b32 s13, s12, 3
    v_and_b32 v5, 31, v0
    v_lshrrev_b32 v6, 5, v0
    s_and_b32 s57, s13, 1
    s_lshr_b32 s56, s13, 1
    s_lshl_b32 s35, s56, 5
    v_add_u32 v18, s35, v5
    v_and_b32 v19, 15, v18
    v_xor_b32 v19, v19, v6
    v_lshlrev_b32 v20, 8, v18
    v_lshl_add_u32 v8, v19, 4, v20
    v_xor_b32 v9, 32, v8
    v_xor_b32 v10, 64, v8
    v_xor_b32 v11, 96, v8
    v_xor_b32 v12, 128, v8
    v_xor_b32 v13, 160, v8
    v_xor_b32 v14, 192, v8
    v_xor_b32 v15, 224, v8
    v_lshl_add_u32 v29, s12, 2, v30
    v_mov_b32 v31, 1
    s_cmp_ge_u32 s12, 4
    s_cbranch_scc1 L_qw_7
    s_setprio 1
    v_lshrrev_b32 v21, 3, v5
    v_and_b32 v21, 1, v21
    v_and_b32 v20, 7, v5
    v_lshrrev_b32 v23, 4, v5
    v_lshl_add_u32 v20, v23, 3, v20
    s_lshl_b32 s34, s51, 5
    s_lshl_b32 s35, s57, 4
    s_add_u32 s34, s34, s35
    v_add_u32 v20, s34, v20
    v_cvt_f32_u32 v24, v21
    v_lshl_add_u32 v25, v20, 1, v21
    v_cmp_eq_u32 vcc, 1, v25
    v_mov_b32 v26, 0x100
    s_nop 0
    v_cndmask_b32 v20, v20, v26, vcc
    v_cndmask_b32_e64 v24, v24, 0, vcc
    v_mul_u32_u24 v25, s49, v20
    v_and_b32 v25, 3, v25
    v_cvt_f32_u32 v25, v25
    v_add_f32 v24, v24, v25
    v_mul_f32 v24, 0x3e800000, v24
    v_cvt_f32_u32 v26, v20
    v_mul_f32 v26, 0x3b000000, v26
    v_lshlrev_b32 v27, 3, v6
    v_cvt_f32_u32 v27, v27
    v_fma_f32 v25, v26, v27, v24
    v_mul_f32 v24, 0x41800000, v26
    v_fract_f32 v24, v24
    v_cos_f32 v22, v24
    v_sub_f32 v25, v25, v24
    v_add_f32 v22, v22, v22
    v_sub_f32 v27, v25, v24
    v_cos_f32 v120, v25
    v_cos_f32 v112, v27
    v_add_f32 v25, v25, v26
    v_sub_f32 v27, v25, v24
    v_cos_f32 v121, v25
    v_cos_f32 v113, v27
    v_add_f32 v25, v25, v26
    v_sub_f32 v27, v25, v24
    v_cos_f32 v122, v25
    v_cos_f32 v114, v27
    v_add_f32 v25, v25, v26
    v_sub_f32 v27, v25, v24
    v_cos_f32 v123, v25
    v_cos_f32 v115, v27
    v_add_f32 v25, v25, v26
    v_sub_f32 v27, v25, v24
    v_cos_f32 v124, v25
    v_cos_f32 v116, v27
    v_add_f32 v25, v25, v26
    v_sub_f32 v27, v25, v24
    v_cos_f32 v125, v25
    v_cos_f32 v117, v27
    v_add_f32 v25, v25, v26
    v_sub_f32 v27, v25, v24
    v_cos_f32 v126, v25
    v_cos_f32 v118, v27
    v_add_f32 v25, v25, v26
    v_sub_f32 v27, v25, v24
    v_cos_f32 v127, v25
    v_cos_f32 v119, v27
    v_mov_b32 v23, v22
    s_mov_b32 s35, 0
L_gen_48:
    v_pk_fma_f32 v[112:113], v[22:23], v[120:121], v[112:113] neg_lo:[0,0,1] neg_hi:[0,0,1]
    v_pk_fma_f32 v[114:115], v[22:23], v[122:123], v[114:115] neg_lo:[0,0,1] neg_hi:[0,0,1]
    v_pk_fma_f32 v[116:117], v[22:23], v[124:125], v[116:117] neg_lo:[0,0,1] neg_hi:[0,0,1]
    v_pk_fma_f32 v[118:119], v[22:23], v[126:127], v[118:119] neg_lo:[0,0,1] neg_hi:[0,0,1]
    v_pk_fma_f32 v[120:121], v[22:23], v[112:113], v[120:121] neg_lo:[0,0,1] neg_hi:[0,0,1]
    v_pk_fma_f32 v[122:123], v[22:23], v[114:115], v[122:123] neg_lo:[0,0,1] neg_hi:[0,0,1]
    v_pk_fma_f32 v[124:125], v[22:23], v[116:117], v[124:125] neg_lo:[0,0,1] neg_hi:[0,0,1]
    v_pk_fma_f32 v[126:127], v[22:23], v[118:119], v[126:127] neg_lo:[0,0,1] neg_hi:[0,0,1]
    s_set_gpr_idx_on s35, gpr_idx(DST)
    s_add_u32 s35, s35, 8
    v_cvt_pk_bf16_f32 v32, v112, v113
    v_cvt_pk_bf16_f32 v33, v114, v115
    v_cvt_pk_bf16_f32 v34, v116, v117
    v_cvt_pk_bf16_f32 v35, v118, v119
    v_cvt_pk_bf16_f32 v36, v120, v121
    v_cvt_pk_bf16_f32 v37, v122, v123
    v_cvt_pk_bf16_f32 v38, v124, v125
    v_cvt_pk_bf16_f32 v39, v126, v127
    s_set_gpr_idx_off
    s_cmp_lt_u32 s35, 32
    s_cbranch_scc1 L_gen_48
    s_lshr_b32 s34, s51, 1
    s_lshl_b32 s34, s34, 6
    s_lshl_b32 s35, s57, 5
    s_add_u32 s34, s34, s35
    v_add_u32 v20, s34, v5
    v_cvt_f32_u32 v26, v20
    v_mul_f32 v26, 0x3b800000, v26
    s_cmp_lt_u32 s12, 4
    s_cselect_b32 s37, 0, 0x3e800000
    v_lshlrev_b32 v27, 4, v6
    v_add_u32 v27, s56, v27
    v_cvt_f32_u32 v27, v27
    v_mul_f32 v27, 0.5, v27
    v_mul_f32 v24, 0x41800000, v26
    v_fract_f32 v24, v24
    v_cos_f32 v22, v24
    v_fma_f32 v25, v26, v27, -v24
    v_add_f32 v25, s37, v25
    v_add_f32 v22, v22, v22
    v_sub_f32 v27, v25, v24
    v_cos_f32 v88, v25
    v_cos_f32 v80, v27
    v_add_f32 v25, v25, v26
    v_sub_f32 v27, v25, v24
    v_cos_f32 v89, v25
    v_cos_f32 v81, v27
    v_add_f32 v25, v25, v26
    v_sub_f32 v27, v25, v24
    v_cos_f32 v90, v25
    v_cos_f32 v82, v27
    v_add_f32 v25, v25, v26
    v_sub_f32 v27, v25, v24
    v_cos_f32 v91, v25
    v_cos_f32 v83, v27
    v_add_f32 v25, v25, v26
    v_sub_f32 v27, v25, v24
    v_cos_f32 v92, v25
    v_cos_f32 v84, v27
    v_add_f32 v25, v25, v26
    v_sub_f32 v27, v25, v24
    v_cos_f32 v93, v25
    v_cos_f32 v85, v27
    v_add_f32 v25, v25, v26
    v_sub_f32 v27, v25, v24
    v_cos_f32 v94, v25
    v_cos_f32 v86, v27
    v_add_f32 v25, v25, v26
    v_sub_f32 v27, v25, v24
    v_cos_f32 v95, v25
    v_cos_f32 v87, v27
    v_mov_b32 v23, v22
    v_and_b32 v21, 1, v20
    v_lshlrev_b32 v21, 15, v21
    v_or_b32 v21, 0x3f80, v21
    v_lshl_add_u32 v24, v6, 4, s12
    v_and_b32 v24, 22, v24
    v_cmp_eq_u32 vcc, 4, v24
    v_pk_fma_f32 v[80:81], v[22:23], v[88:89], v[80:81] neg_lo:[0,0,1] neg_hi:[0,0,1]
    v_pk_fma_f32 v[82:83], v[22:23], v[90:91], v[82:83] neg_lo:[0,0,1] neg_hi:[0,0,1]
    v_pk_fma_f32 v[84:85], v[22:23], v[92:93], v[84:85] neg_lo:[0,0,1] neg_hi:[0,0,1]
    v_pk_fma_f32 v[86:87], v[22:23], v[94:95], v[86:87] neg_lo:[0,0,1] neg_hi:[0,0,1]
    v_cvt_pk_bf16_f32 v136, v80, v81
    v_cvt_pk_bf16_f32 v137, v82, v83
    v_cvt_pk_bf16_f32 v138, v84, v85
    v_cvt_pk_bf16_f32 v139, v86, v87
    v_and_b32 v24, 0xffff0000, v136
    v_or_b32 v24, v21, v24
    v_cndmask_b32 v136, v136, v24, vcc
    v_pk_fma_f32 v[88:89], v[22:23], v[80:81], v[88:89] neg_lo:[0,0,1] neg_hi:[0,0,1]
    v_pk_fma_f32 v[90:91], v[22:23], v[82:83], v[90:91] neg_lo:[0,0,1] neg_hi:[0,0,1]
    v_pk_fma_f32 v[92:93], v[22:23], v[84:85], v[92:93] neg_lo:[0,0,1] neg_hi:[0,0,1]
    v_pk_fma_f32 v[94:95], v[22:23], v[86:87], v[94:95] neg_lo:[0,0,1] neg_hi:[0,0,1]
    v_cvt_pk_bf16_f32 v140, v88, v89
    v_cvt_pk_bf16_f32 v141, v90, v91
    v_cvt_pk_bf16_f32 v142, v92, v93
    v_cvt_pk_bf16_f32 v143, v94, v95
    v_pk_fma_f32 v[80:81], v[22:23], v[88:89], v[80:81] neg_lo:[0,0,1] neg_hi:[0,0,1]
    v_pk_fma_f32 v[82:83], v[22:23], v[90:91], v[82:83] neg_lo:[0,0,1] neg_hi:[0,0,1]
    v_pk_fma_f32 v[84:85], v[22:23], v[92:93], v[84:85] neg_lo:[0,0,1] neg_hi:[0,0,1]
    v_pk_fma_f32 v[86:87], v[22:23], v[94:95], v[86:87] neg_lo:[0,0,1] neg_hi:[0,0,1]
    v_cvt_pk_bf16_f32 v144, v80, v81
    v_cvt_pk_bf16_f32 v145, v82, v83
    v_cvt_pk_bf16_f32 v146, v84, v85
    v_cvt_pk_bf16_f32 v147, v86, v87
    s_waitcnt lgkmcnt(0)
    s_mov_b32 s33, 0
    s_movk_i32 s36, 0xf2
    s_mov_b32 s17, 6
    s_mov_b32 s18, 9
    s_mov_b32 s42, 5
    s_mul_i32 s41, s57, 1152
    s_add_u32 s41, s41, 0x10000
    v_lshl_add_u32 v1, s57, 10, v3
    v_min_u32 v2, 17, v5
    v_lshlrev_b32 v2, 4, v2
    v_mul_u32_u24 v7, 288, v6
    v_add3_u32 v2, v2, v7, s41
    s_add_u32 s41, s41, 0x12000
    s_mov_b32 s34, 0
    s_lshl_b32 s14, s50, 1
    s_add_u32 s14, s14, s56
    s_lshl_b32 s16, s14, 7
    s_add_u32 s16, s16, 0x220000
    s_lshl_b32 s14, s14, 15
    s_lshl_b32 s15, s51, 12
    s_add_u32 s14, s14, s15
    s_lshl_b32 s15, s57, 11
    s_add_u32 s14, s14, s15
    s_add_u32 s14, s14, 0x800400
    s_xor_b32 s35, s13, 1
    s_lshl_b32 s35, s35, 10
    s_add_u32 s35, s35, 0x26500
    v_add_u32 v4, s35, v3
    v_min_u32 v25, 2, v0
    v_lshl_add_u32 v25, v25, 2, v30
    s_mov_b32 s24, s46
    s_mov_b32 s25, s47
    s_lshl_b32 s35, s13, 10
    s_add_u32 s35, s35, 0x26500
    v_add_u32 v7, s35, v3
    s_lshl_b32 s37, s57, 12
    s_add_u32 s37, s37, 0x20000
    v_lshl_add_u32 v21, v18, 2, s37
    v_lshl_add_u32 v21, v6, 10, v21
    s_lshl_b32 s43, s56, 7
    s_lshl_b32 s40, s51, 18
    s_add_u32 s40, s40, s43
    s_add_u32 s43, s43, s37
    s_lshl_b32 s37, s57, 17
    s_add_u32 s40, s40, s37
    s_lshl_b32 s37, s50, 8
    s_add_u32 s40, s40, s37
    s_add_u32 s40, s40, 0x300000
    s_waitcnt vmcnt(0)
    s_setprio 1
    s_branch L_fr_49y
L_fr_49:
    s_sub_u32 s90, s90, 1
    s_cbranch_scc1 L_exit_2
L_fr_49y:
    ds_read_b32 v24, v25 offset:6416
    s_waitcnt lgkmcnt(0)
    v_cmp_eq_u32 vcc, 0, v24
    s_cbranch_vccnz L_fr_49
    ds_read_b128 v[96:99], v8 offset:0
    ds_read_b128 v[100:103], v9 offset:0
    ds_read_b128 v[108:111], v10 offset:0
    ds_read_b128 v[112:115], v11 offset:0
    ds_read_b128 v[116:119], v12 offset:0
    ds_read_b128 v[120:123], v13 offset:0
    ds_read_b128 v[124:127], v14 offset:0
    ds_read_b128 v[128:131], v15 offset:0
L_fr_49x:
    s_waitcnt lgkmcnt(7)
    v_mfma_f32_32x32x16_bf16 v[64:79], v[32:35], v[96:99], 0
    s_waitcnt lgkmcnt(6)
    v_mfma_f32_32x32x16_bf16 v[64:79], v[36:39], v[100:103], v[64:79]
    s_waitcnt lgkmcnt(5)
    v_mfma_f32_32x32x16_bf16 v[64:79], v[40:43], v[108:111], v[64:79]
    s_waitcnt lgkmcnt(4)
    v_mfma_f32_32x32x16_bf16 v[64:79], v[44:47], v[112:115], v[64:79]
    s_waitcnt lgkmcnt(3)
    v_mfma_f32_32x32x16_bf16 v[64:79], v[48:51], v[116:119], v[64:79]
    s_waitcnt lgkmcnt(2)
    v_mfma_f32_32x32x16_bf16 v[64:79], v[52:55], v[120:123], v[64:79]
    s_waitcnt lgkmcnt(1)
    v_mfma_f32_32x32x16_bf16 v[64:79], v[56:59], v[124:127], v[64:79]
    s_waitcnt lgkmcnt(0)
    v_mfma_f32_32x32x16_bf16 v[64:79], v[60:63], v[128:131], v[64:79]
    v_mov_b32 v28, 1
    s_mov_b64 exec, 1
    ds_write_b32 v29, v28 offset:16
    s_mov_b64 exec, -1
    v_pk_fma_f32 v[88:89], v[22:23], v[80:81], v[88:89] neg_lo:[0,0,1] neg_hi:[0,0,1]
    v_pk_fma_f32 v[90:91], v[22:23], v[82:83], v[90:91] neg_lo:[0,0,1] neg_hi:[0,0,1]
    v_pk_fma_f32 v[92:93], v[22:23], v[84:85], v[92:93] neg_lo:[0,0,1] neg_hi:[0,0,1]
    v_pk_fma_f32 v[94:95], v[22:23], v[86:87], v[94:95] neg_lo:[0,0,1] neg_hi:[0,0,1]
    v_cvt_pk_bf16_f32 v148, v88, v89
    v_cvt_pk_bf16_f32 v149, v90, v91
    v_cvt_pk_bf16_f32 v150, v92, v93
    v_cvt_pk_bf16_f32 v151, v94, v95
    v_pk_fma_f32 v[80:81], v[22:23], v[88:89], v[80:81] neg_lo:[0,0,1] neg_hi:[0,0,1]
    v_pk_fma_f32 v[82:83], v[22:23], v[90:91], v[82:83] neg_lo:[0,0,1] neg_hi:[0,0,1]
    v_pk_fma_f32 v[84:85], v[22:23], v[92:93], v[84:85] neg_lo:[0,0,1] neg_hi:[0,0,1]
    v_pk_fma_f32 v[86:87], v[22:23], v[94:95], v[86:87] neg_lo:[0,0,1] neg_hi:[0,0,1]
    v_cvt_pk_bf16_f32 v152, v80, v81
    v_cvt_pk_bf16_f32 v153, v82, v83
    v_cvt_pk_bf16_f32 v154, v84, v85
    v_cvt_pk_bf16_f32 v155, v86, v87
    v_pk_fma_f32 v[88:89], v[22:23], v[80:81], v[88:89] neg_lo:[0,0,1] neg_hi:[0,0,1]
    v_pk_fma_f32 v[90:91], v[22:23], v[82:83], v[90:91] neg_lo:[0,0,1] neg_hi:[0,0,1]
    v_pk_fma_f32 v[92:93], v[22:23], v[84:85], v[92:93] neg_lo:[0,0,1] neg_hi:[0,0,1]
    v_pk_fma_f32 v[94:95], v[22:23], v[86:87], v[94:95] neg_lo:[0,0,1] neg_hi:[0,0,1]
    v_cvt_pk_bf16_f32 v156, v88, v89
    v_cvt_pk_bf16_f32 v157, v90, v91
    v_cvt_pk_bf16_f32 v158, v92, v93
    v_cvt_pk_bf16_f32 v159, v94, v95
    ds_read_b32 v24, v25 offset:6448
    ds_read_b128 v[96:99], v8 offset:16384
    ds_read_b128 v[100:103], v9 offset:16384
    ds_read_b128 v[108:111], v10 offset:16384
    ds_read_b128 v[112:115], v11 offset:16384
    ds_read_b128 v[116:119], v12 offset:16384
    ds_read_b128 v[120:123], v13 offset:16384
    ds_read_b128 v[124:127], v14 offset:16384
    ds_read_b128 v[128:131], v15 offset:16384
    v_pk_fma_f32 v[80:81], v[22:23], v[88:89], v[80:81] neg_lo:[0,0,1] neg_hi:[0,0,1]
    v_pk_fma_f32 v[82:83], v[22:23], v[90:91], v[82:83] neg_lo:[0,0,1] neg_hi:[0,0,1]
    v_pk_fma_f32 v[84:85], v[22:23], v[92:93], v[84:85] neg_lo:[0,0,1] neg_hi:[0,0,1]
    v_pk_fma_f32 v[86:87], v[22:23], v[94:95], v[86:87] neg_lo:[0,0,1] neg_hi:[0,0,1]
    v_cvt_pk_bf16_f32 v164, v80, v81
    v_cvt_pk_bf16_f32 v165, v82, v83
    v_cvt_pk_bf16_f32 v166, v84, v85
    v_cvt_pk_bf16_f32 v167, v86, v87
    v_pk_fma_f32 v[88:89], v[22:23], v[80:81], v[88:89] neg_lo:[0,0,1] neg_hi:[0,0,1]
    v_pk_fma_f32 v[90:91], v[22:23], v[82:83], v[90:91] neg_lo:[0,0,1] neg_hi:[0,0,1]
    v_pk_fma_f32 v[92:93], v[22:23], v[84:85], v[92:93] neg_lo:[0,0,1] neg_hi:[0,0,1]
    v_pk_fma_f32 v[94:95], v[22:23], v[86:87], v[94:95] neg_lo:[0,0,1] neg_hi:[0,0,1]
    v_cvt_pk_bf16_f32 v160, v88, v89
    v_cvt_pk_bf16_f32 v161, v90, v91
    v_cvt_pk_bf16_f32 v162, v92, v93
    v_cvt_pk_bf16_f32 v163, v94, v95
    s_waitcnt lgkmcnt(8)
    v_cmp_eq_u32 vcc, 0, v24
    s_cbranch_vccz L_fr_50x
L_fr_50:
    s_sub_u32 s90, s90, 1
    s_cbranch_scc1 L_exit_2
L_fr_50y:
    ds_read_b32 v24, v25 offset:6448
    s_waitcnt lgkmcnt(0)
    v_cmp_eq_u32 vcc, 0, v24
    s_cbranch_vccnz L_fr_50
    ds_read_b128 v[96:99], v8 offset:16384
    ds_read_b128 v[100:103], v9 offset:16384
    ds_read_b128 v[108:111], v10 offset:16384
    ds_read_b128 v[112:115], v11 offset:16384
    ds_read_b128 v[116:119], v12 offset:16384
    ds_read_b128 v[120:123], v13 offset:16384
    ds_read_b128 v[124:127], v14 offset:16384
    ds_read_b128 v[128:131], v15 offset:16384
L_fr_50x:
    s_waitcnt lgkmcnt(7)
    v_mfma_f32_32x32x16_bf16 v[80:95], v[32:35], v[96:99], 0
    ds_read_b32 v24, v25 offset:6480
    ds_read_b128 v[96:99], v8 offset:32768
    s_waitcnt lgkmcnt(8)
    v_mfma_f32_32x32x16_bf16 v[80:95], v[36:39], v[100:103], v[80:95]
    ds_read_b128 v[100:103], v9 offset:32768
    s_waitcnt lgkmcnt(8)
    v_mfma_f32_32x32x16_bf16 v[80:95], v[40:43], v[108:111], v[80:95]
    ds_read_b128 v[108:111], v10 offset:32768
    v_xor_b32 v65, 0x80000000, v65
    v_xor_b32 v67, 0x80000000, v67
    v_xor_b32 v69, 0x80000000, v69
    v_xor_b32 v71, 0x80000000, v71
    s_waitcnt lgkmcnt(8)
    v_mfma_f32_32x32x16_bf16 v[80:95], v[44:47], v[112:115], v[80:95]
    ds_read_b128 v[112:115], v11 offset:32768
    v_xor_b32 v73, 0x80000000, v73
    v_xor_b32 v75, 0x80000000, v75
    v_xor_b32 v77, 0x80000000, v77
    v_xor_b32 v79, 0x80000000, v79
    s_waitcnt lgkmcnt(8)
    v_mfma_f32_32x32x16_bf16 v[80:95], v[48:51], v[116:119], v[80:95]
    ds_read_b128 v[116:119], v12 offset:32768
    s_waitcnt lgkmcnt(8)
    v_mfma_f32_32x32x16_bf16 v[80:95], v[52:55], v[120:123], v[80:95]
    ds_read_b128 v[120:123], v13 offset:32768
    s_waitcnt lgkmcnt(8)
    v_mfma_f32_32x32x16_bf16 v[80:95], v[56:59], v[124:127], v[80:95]
    ds_read_b128 v[124:127], v14 offset:32768
    s_waitcnt lgkmcnt(8)
    v_mfma_f32_32x32x16_bf16 v[80:95], v[60:63], v[128:131], v[80:95]
    ds_read_b128 v[128:131], v15 offset:32768
    s_waitcnt lgkmcnt(8)
    v_cmp_eq_u32 vcc, 0, v24
    s_cbranch_vccz L_fr_51x
L_fr_51:
    s_sub_u32 s90, s90, 1
    s_cbranch_scc1 L_exit_2
L_fr_51y:
    ds_read_b32 v24, v25 offset:6480
    s_waitcnt lgkmcnt(0)
    v_cmp_eq_u32 vcc, 0, v24
    s_cbranch_vccnz L_fr_51
    ds_read_b128 v[96:99], v8 offset:32768
    ds_read_b128 v[100:103], v9 offset:32768
    ds_read_b128 v[108:111], v10 offset:32768
    ds_read_b128 v[112:115], v11 offset:32768
    ds_read_b128 v[116:119], v12 offset:32768
    ds_read_b128 v[120:123], v13 offset:32768
    ds_read_b128 v[124:127], v14 offset:32768
    ds_read_b128 v[128:131], v15 offset:32768
L_fr_51x:
    s_waitcnt lgkmcnt(7)
    v_mfma_f32_32x32x16_bf16 v[64:79], v[32:35], v[96:99], v[64:79]
    ds_read_b32 v24, v25 offset:6512
    ds_read_b128 v[96:99], v8 offset:49152
    s_waitcnt lgkmcnt(8)
    v_mfma_f32_32x32x16_bf16 v[64:79], v[36:39], v[100:103], v[64:79]
    ds_read_b128 v[100:103], v9 offset:49152
    s_waitcnt lgkmcnt(8)
    v_mfma_f32_32x32x16_bf16 v[64:79], v[40:43], v[108:111], v[64:79]
    ds_read_b128 v[108:111], v10 offset:49152
    v_xor_b32 v81, 0x80000000, v81
    v_xor_b32 v83, 0x80000000, v83
    v_xor_b32 v85, 0x80000000, v85
    v_xor_b32 v87, 0x80000000, v87
    s_waitcnt lgkmcnt(8)
    v_mfma_f32_32x32x16_bf16 v[64:79], v[44:47], v[112:115], v[64:79]
    ds_read_b128 v[112:115], v11 offset:49152
    v_xor_b32 v89, 0x80000000, v89
    v_xor_b32 v91, 0x80000000, v91
    v_xor_b32 v93, 0x80000000, v93
    v_xor_b32 v95, 0x80000000, v95
    s_waitcnt lgkmcnt(8)
    v_mfma_f32_32x32x16_bf16 v[64:79], v[48:51], v[116:119], v[64:79]
    ds_read_b128 v[116:119], v12 offset:49152
    s_waitcnt lgkmcnt(8)
    v_mfma_f32_32x32x16_bf16 v[64:79], v[52:55], v[120:123], v[64:79]
    ds_read_b128 v[120:123], v13 offset:49152
    s_waitcnt lgkmcnt(8)
    v_mfma_f32_32x32x16_bf16 v[64:79], v[56:59], v[124:127], v[64:79]
    ds_read_b128 v[124:127], v14 offset:49152
    s_waitcnt lgkmcnt(8)
    v_mfma_f32_32x32x16_bf16 v[64:79], v[60:63], v[128:131], v[64:79]
    ds_read_b128 v[128:131], v15 offset:49152
    s_waitcnt lgkmcnt(8)
    v_cmp_eq_u32 vcc, 0, v24
    s_cbranch_vccz L_fr_52x
L_fr_52:
    s_sub_u32 s90, s90, 1
    s_cbranch_scc1 L_exit_2
L_fr_52y:
    ds_read_b32 v24, v25 offset:6512
    s_waitcnt lgkmcnt(0)
    v_cmp_eq_u32 vcc, 0, v24
    s_cbranch_vccnz L_fr_52
    ds_read_b128 v[96:99], v8 offset:49152
    ds_read_b128 v[100:103], v9 offset:49152
    ds_read_b128 v[108:111], v10 offset:49152
    ds_read_b128 v[112:115], v11 offset:49152
    ds_read_b128 v[116:119], v12 offset:49152
    ds_read_b128 v[120:123], v13 offset:49152
    ds_read_b128 v[124:127], v14 offset:49152
    ds_read_b128 v[128:131], v15 offset:49152
L_fr_52x:
    s_waitcnt lgkmcnt(7)
    v_mfma_f32_32x32x16_bf16 v[80:95], v[32:35], v[96:99], v[80:95]
    s_waitcnt lgkmcnt(6)
    v_mfma_f32_32x32x16_bf16 v[80:95], v[36:39], v[100:103], v[80:95]
    s_waitcnt lgkmcnt(5)
    v_mfma_f32_32x32x16_bf16 v[80:95], v[40:43], v[108:111], v[80:95]
    s_waitcnt lgkmcnt(4)
    v_mfma_f32_32x32x16_bf16 v[80:95], v[44:47], v[112:115], v[80:95]
    s_waitcnt lgkmcnt(3)
    v_mfma_f32_32x32x16_bf16 v[80:95], v[48:51], v[116:119], v[80:95]
    s_waitcnt lgkmcnt(2)
    v_mfma_f32_32x32x16_bf16 v[80:95], v[52:55], v[120:123], v[80:95]
    s_waitcnt lgkmcnt(1)
    v_mfma_f32_32x32x16_bf16 v[80:95], v[56:59], v[124:127], v[80:95]
    s_waitcnt lgkmcnt(0)
    v_mfma_f32_32x32x16_bf16 v[80:95], v[60:63], v[128:131], v[80:95]
    v_mov_b32 v28, 4
    s_mov_b64 exec, 1
    ds_write_b32 v29, v28 offset:16
    s_mov_b64 exec, -1
    s_mov_b64 vcc, -1
    s_nop 7
    s_nop 1
    v_add_f32 v64, v64, v80
    v_add_f32 v68, v68, v84
    v_cvt_pk_bf16_f32 v96, v64, v68
    ds_write_b32 v21, v96 offset:0
    v_add_f32_e64 v65, -v65, -v85
    v_sub_f32 v69, v81, v69
    v_cvt_pk_bf16_f32 v97, v65, v69
    ds_write_b32 v21, v97 offset:256
    v_sub_f32 v66, v66, v82
    v_sub_f32 v70, v70, v86
    v_cvt_pk_bf16_f32 v98, v66, v70
    ds_write_b32 v21, v98 offset:512
    v_sub_f32 v67, v87, v67
    v_add_f32_e64 v71, -v71, -v83
    v_cvt_pk_bf16_f32 v99, v67, v71
    ds_write_b32 v21, v99 offset:768
    v_add_f32 v72, v72, v88
    v_add_f32 v76, v76, v92
    v_cvt_pk_bf16_f32 v100, v72, v76
    ds_write_b32 v21, v100 offset:2048
    v_add_f32_e64 v73, -v73, -v93
    v_sub_f32 v77, v89, v77
    v_cvt_pk_bf16_f32 v101, v73, v77
    ds_write_b32 v21, v101 offset:2304
    v_sub_f32 v74, v74, v90
    v_sub_f32 v78, v78, v94
    v_cvt_pk_bf16_f32 v102, v74, v78
    ds_write_b32 v21, v102 offset:2560
    v_sub_f32 v75, v95, v75
    v_add_f32_e64 v79, -v79, -v91
    v_cvt_pk_bf16_f32 v103, v75, v79
    ds_write_b32 v21, v103 offset:2816
    s_waitcnt lgkmcnt(0)
    s_mov_b64 exec, 1
    ds_write_b32 v29, v31 offset:48
    s_mov_b64 exec, -1
    v_and_b32 v31, -8, v29
    s_setprio 0
L_qw2_47x:
    ds_read_b64 v[96:97], v30 offset:0
    ds_read_b64 v[98:99], v31 offset:32
    ds_read_b128 v[32:35], v7
    ds_read_b128 v[8:11], v1 offset:0
    ds_read_b128 v[24:27], v4
    ds_read_b128 v[16:19], v2 offset:0
    ds_read_b128 v[20:23], v2 offset:576
    s_waitcnt lgkmcnt(5)
    v_min_u32 v96, v96, v97
    v_min_u32 v98, v98, v99
    v_readfirstlane_b32 s38, v96
    v_readfirstlane_b32 s35, v98
    s_cmp_ge_u32 s38, 9
    s_cbranch_scc0 L_qw2_47
    s_cmp_ge_u32 s35, 5
    s_cbranch_scc0 L_qw2_47
    s_setprio 2
    s_branch L_nq_46y
L_qw2_47:
    s_sleep 1
    s_sub_u32 s90, s90, 1
    s_cbranch_scc0 L_qw2_47x
    s_branch L_exit_2
L_nq_46:
    s_sleep 1
    s_sub_u32 s90, s90, 1
    s_cbranch_scc0 L_nq_46x
    s_branch L_exit_2
L_qw_7:
    v_and_b32 v23, 1, v1
    v_lshrrev_b32 v25, 2, v2
    v_and_b32 v26, 3, v2
    v_lshl_add_u32 v27, v6, 3, v25
    v_lshlrev_b32 v27, 7, v27
    v_lshlrev_b32 v28, 5, v23
    v_lshl_add_u32 v28, v26, 3, v28
    s_lshl_b32 s35, s57, 6
    v_add_u32 v28, s35, v28
    v_lshrrev_b32 v24, 1, v25
    v_lshlrev_b32 v24, 6, v24
    v_xor_b32 v28, v28, v24
    v_add_u32 v16, v27, v28
    v_add_u32 v16, 0x10000, v16
    s_lshl_b32 s35, s13, 10
    s_add_u32 s35, s35, 0x22000
    v_add_u32 v17, s35, v3
    s_lshr_b32 s34, s51, 1
    s_lshl_b32 s34, s34, 6
    s_lshl_b32 s35, s57, 5
    s_add_u32 s34, s34, s35
    v_add_u32 v20, s34, v5
    v_cvt_f32_u32 v26, v20
    v_mul_f32 v26, 0x3b800000, v26
    s_cmp_lt_u32 s12, 4
    s_cselect_b32 s37, 0, 0x3e800000
    v_lshlrev_b32 v27, 4, v6
    v_add_u32 v27, s56, v27
    v_cvt_f32_u32 v27, v27
    v_mul_f32 v27, 0.5, v27
    v_mul_f32 v24, 0x41800000, v26
    v_fract_f32 v24, v24
    v_cos_f32 v22, v24
    v_fma_f32 v25, v26, v27, -v24
    v_add_f32 v25, s37, v25
    v_add_f32 v22, v22, v22
    v_sub_f32 v27, v25, v24
    v_cos_f32 v120, v25
    v_cos_f32 v112, v27
    v_add_f32 v25, v25, v26
    v_sub_f32 v27, v25, v24
    v_cos_f32 v121, v25
    v_cos_f32 v113, v27
    v_add_f32 v25, v25, v26
    v_sub_f32 v27, v25, v24
    v_cos_f32 v122, v25
    v_cos_f32 v114, v27
    v_add_f32 v25, v25, v26
    v_sub_f32 v27, v25, v24
    v_cos_f32 v123, v25
    v_cos_f32 v115, v27
    v_add_f32 v25, v25, v26
    v_sub_f32 v27, v25, v24
    v_cos_f32 v124, v25
    v_cos_f32 v116, v27
    v_add_f32 v25, v25, v26
    v_sub_f32 v27, v25, v24
    v_cos_f32 v125, v25
    v_cos_f32 v117, v27
    v_add_f32 v25, v25, v26
    v_sub_f32 v27, v25, v24
    v_cos_f32 v126, v25
    v_cos_f32 v118, v27
    v_add_f32 v25, v25, v26
    v_sub_f32 v27, v25, v24
    v_cos_f32 v127, v25
    v_cos_f32 v119, v27
    v_mov_b32 v23, v22
    v_and_b32 v21, 1, v20
    v_lshlrev_b32 v21, 15, v21
    v_or_b32 v21, 0x3f80, v21
    v_lshl_add_u32 v24, v6, 4, s12
    v_and_b32 v24, 22, v24
    v_cmp_eq_u32 vcc, 4, v24
    v_pk_fma_f32 v[112:113], v[22:23], v[120:121], v[112:113] neg_lo:[0,0,1] neg_hi:[0,0,1]
    v_pk_fma_f32 v[114:115], v[22:23], v[122:123], v[114:115] neg_lo:[0,0,1] neg_hi:[0,0,1]
    v_pk_fma_f32 v[116:117], v[22:23], v[124:125], v[116:117] neg_lo:[0,0,1] neg_hi:[0,0,1]
    v_pk_fma_f32 v[118:119], v[22:23], v[126:127], v[118:119] neg_lo:[0,0,1] neg_hi:[0,0,1]
    v_cvt_pk_bf16_f32 v136, v112, v113
    v_cvt_pk_bf16_f32 v137, v114, v115
    v_cvt_pk_bf16_f32 v138, v116, v117
    v_cvt_pk_bf16_f32 v139, v118, v119
    v_and_b32 v24, 0xffff0000, v136
    v_or_b32 v24, v21, v24
    v_cndmask_b32 v136, v136, v24, vcc
    v_pk_fma_f32 v[120:121], v[22:23], v[112:113], v[120:121] neg_lo:[0,0,1] neg_hi:[0,0,1]
    v_pk_fma_f32 v[122:123], v[22:23], v[114:115], v[122:123] neg_lo:[0,0,1] neg_hi:[0,0,1]
    v_pk_fma_f32 v[124:125], v[22:23], v[116:117], v[124:125] neg_lo:[0,0,1] neg_hi:[0,0,1]
    v_pk_fma_f32 v[126:127], v[22:23], v[118:119], v[126:127] neg_lo:[0,0,1] neg_hi:[0,0,1]
    v_cvt_pk_bf16_f32 v140, v120, v121
    v_cvt_pk_bf16_f32 v141, v122, v123
    v_cvt_pk_bf16_f32 v142, v124, v125
    v_cvt_pk_bf16_f32 v143, v126, v127
    v_pk_fma_f32 v[112:113], v[22:23], v[120:121], v[112:113] neg_lo:[0,0,1] neg_hi:[0,0,1]
    v_pk_fma_f32 v[114:115], v[22:23], v[122:123], v[114:115] neg_lo:[0,0,1] neg_hi:[0,0,1]
    v_pk_fma_f32 v[116:117], v[22:23], v[124:125], v[116:117] neg_lo:[0,0,1] neg_hi:[0,0,1]
    v_pk_fma_f32 v[118:119], v[22:23], v[126:127], v[118:119] neg_lo:[0,0,1] neg_hi:[0,0,1]
    v_cvt_pk_bf16_f32 v144, v112, v113
    v_cvt_pk_bf16_f32 v145, v114, v115
    v_cvt_pk_bf16_f32 v146, v116, v117
    v_cvt_pk_bf16_f32 v147, v118, v119
    v_pk_fma_f32 v[120:121], v[22:23], v[112:113], v[120:121] neg_lo:[0,0,1] neg_hi:[0,0,1]
    v_pk_fma_f32 v[122:123], v[22:23], v[114:115], v[122:123] neg_lo:[0,0,1] neg_hi:[0,0,1]
    v_pk_fma_f32 v[124:125], v[22:23], v[116:117], v[124:125] neg_lo:[0,0,1] neg_hi:[0,0,1]
    v_pk_fma_f32 v[126:127], v[22:23], v[118:119], v[126:127] neg_lo:[0,0,1] neg_hi:[0,0,1]
    v_cvt_pk_bf16_f32 v148, v120, v121
    v_cvt_pk_bf16_f32 v149, v122, v123
    v_cvt_pk_bf16_f32 v150, v124, v125
    v_cvt_pk_bf16_f32 v151, v126, v127
    v_pk_fma_f32 v[112:113], v[22:23], v[120:121], v[112:113] neg_lo:[0,0,1] neg_hi:[0,0,1]
    v_pk_fma_f32 v[114:115], v[22:23], v[122:123], v[114:115] neg_lo:[0,0,1] neg_hi:[0,0,1]
    v_pk_fma_f32 v[116:117], v[22:23], v[124:125], v[116:117] neg_lo:[0,0,1] neg_hi:[0,0,1]
    v_pk_fma_f32 v[118:119], v[22:23], v[126:127], v[118:119] neg_lo:[0,0,1] neg_hi:[0,0,1]
    v_cvt_pk_bf16_f32 v152, v112, v113
    v_cvt_pk_bf16_f32 v153, v114, v115
    v_cvt_pk_bf16_f32 v154, v116, v117
    v_cvt_pk_bf16_f32 v155, v118, v119
    v_pk_fma_f32 v[120:121], v[22:23], v[112:113], v[120:121] neg_lo:[0,0,1] neg_hi:[0,0,1]
    v_pk_fma_f32 v[122:123], v[22:23], v[114:115], v[122:123] neg_lo:[0,0,1] neg_hi:[0,0,1]
    v_pk_fma_f32 v[124:125], v[22:23], v[116:117], v[124:125] neg_lo:[0,0,1] neg_hi:[0,0,1]
    v_pk_fma_f32 v[126:127], v[22:23], v[118:119], v[126:127] neg_lo:[0,0,1] neg_hi:[0,0,1]
    v_cvt_pk_bf16_f32 v156, v120, v121
    v_cvt_pk_bf16_f32 v157, v122, v123
    v_cvt_pk_bf16_f32 v158, v124, v125
    v_cvt_pk_bf16_f32 v159, v126, v127
    v_pk_fma_f32 v[112:113], v[22:23], v[120:121], v[112:113] neg_lo:[0,0,1] neg_hi:[0,0,1]
    v_pk_fma_f32 v[114:115], v[22:23], v[122:123], v[114:115] neg_lo:[0,0,1] neg_hi:[0,0,1]
    v_pk_fma_f32 v[116:117], v[22:23], v[124:125], v[116:117] neg_lo:[0,0,1] neg_hi:[0,0,1]
    v_pk_fma_f32 v[118:119], v[22:23], v[126:127], v[118:119] neg_lo:[0,0,1] neg_hi:[0,0,1]
    v_cvt_pk_bf16_f32 v164, v112, v113
    v_cvt_pk_bf16_f32 v165, v114, v115
    v_cvt_pk_bf16_f32 v166, v116, v117
    v_cvt_pk_bf16_f32 v167, v118, v119
    v_pk_fma_f32 v[120:121], v[22:23], v[112:113], v[120:121] neg_lo:[0,0,1] neg_hi:[0,0,1]
    v_pk_fma_f32 v[122:123], v[22:23], v[114:115], v[122:123] neg_lo:[0,0,1] neg_hi:[0,0,1]
    v_pk_fma_f32 v[124:125], v[22:23], v[116:117], v[124:125] neg_lo:[0,0,1] neg_hi:[0,0,1]
    v_pk_fma_f32 v[126:127], v[22:23], v[118:119], v[126:127] neg_lo:[0,0,1] neg_hi:[0,0,1]
    v_cvt_pk_bf16_f32 v160, v120, v121
    v_cvt_pk_bf16_f32 v161, v122, v123
    v_cvt_pk_bf16_f32 v162, v124, v125
    v_cvt_pk_bf16_f32 v163, v126, v127
    s_waitcnt lgkmcnt(0)
    s_mov_b32 s33, 0
    s_movk_i32 s36, 0xf2
    s_mov_b32 s17, 7
    s_mov_b32 s18, 9
    s_mov_b32 s42, 6
    s_mul_i32 s41, s57, 1152
    s_add_u32 s41, s41, 0x10000
    v_lshl_add_u32 v1, s57, 10, v3
    v_min_u32 v2, 17, v5
    v_lshlrev_b32 v2, 4, v2
    v_mul_u32_u24 v7, 288, v6
    v_add3_u32 v2, v2, v7, s41
    s_add_u32 s41, s41, 0x12000
    s_mov_b32 s34, 0
    s_lshl_b32 s14, s50, 1
    s_add_u32 s14, s14, s56
    s_lshl_b32 s16, s14, 7
    s_add_u32 s16, s16, 0x220000
    s_lshl_b32 s14, s14, 15
    s_lshl_b32 s15, s51, 12
    s_add_u32 s14, s14, s15
    s_lshl_b32 s15, s57, 11
    s_add_u32 s14, s14, s15
    s_add_u32 s14, s14, 0x800000
    s_xor_b32 s35, s13, 1
    s_lshl_b32 s35, s35, 10
    s_add_u32 s35, s35, 0x22000
    v_add_u32 v4, s35, v3
    v_min_u32 v25, 2, v0
    v_lshl_add_u32 v25, v25, 2, v30
    s_mov_b32 s24, s46
    s_mov_b32 s25, s47
    v_and_b32 v31, -8, v29
    s_waitcnt vmcnt(0)
    s_setprio 2
    s_branch L_qr_54y
L_qr_54:
    s_sub_u32 s90, s90, 1
    s_cbranch_scc1 L_exit_2
L_qr_54y:
    ds_read_b32 v24, v25 offset:6432
    s_waitcnt lgkmcnt(0)
    v_cmp_eq_u32 vcc, 0, v24
    s_cbranch_vccnz L_qr_54
    ds_read_b128 v[80:83], v8 offset:0
    ds_read_b64_tr_b16 v[32:33], v16 offset:0
    ds_read_b64_tr_b16 v[34:35], v16 offset:512
    ds_read_b128 v[84:87], v9 offset:0
    ds_read_b64_tr_b16 v[36:37], v16 offset:2048
    ds_read_b64_tr_b16 v[38:39], v16 offset:2560
    ds_read_b128 v[88:91], v10 offset:0
    ds_read_b64_tr_b16 v[40:41], v16 offset:4096
    ds_read_b64_tr_b16 v[42:43], v16 offset:4608
    ds_read_b128 v[92:95], v11 offset:0
    ds_read_b64_tr_b16 v[44:45], v16 offset:6144
    ds_read_b64_tr_b16 v[46:47], v16 offset:6656
L_qr_54x:
    s_waitcnt lgkmcnt(9)
    v_mfma_f32_32x32x16_bf16 v[64:79], v[32:35], v[80:83], 0
    ds_read_b128 v[96:99], v12 offset:0
    ds_read_b64_tr_b16 v[48:49], v16 offset:8192
    ds_read_b64_tr_b16 v[50:51], v16 offset:8704
    s_waitcnt lgkmcnt(9)
    v_mfma_f32_32x32x16_bf16 v[64:79], v[36:39], v[84:87], v[64:79]
    ds_read_b128 v[100:103], v13 offset:0
    ds_read_b64_tr_b16 v[52:53], v16 offset:10240
    ds_read_b64_tr_b16 v[54:55], v16 offset:10752
    s_waitcnt lgkmcnt(9)
    v_mfma_f32_32x32x16_bf16 v[64:79], v[40:43], v[88:91], v[64:79]
    ds_read_b128 v[80:83], v14 offset:0
    ds_read_b64_tr_b16 v[56:57], v16 offset:12288
    ds_read_b64_tr_b16 v[58:59], v16 offset:12800
    s_waitcnt lgkmcnt(9)
    v_mfma_f32_32x32x16_bf16 v[64:79], v[44:47], v[92:95], v[64:79]
    ds_read_b128 v[84:87], v15 offset:0
    ds_read_b64_tr_b16 v[60:61], v16 offset:14336
    ds_read_b64_tr_b16 v[62:63], v16 offset:14848
    s_waitcnt lgkmcnt(9)
    v_mfma_f32_32x32x16_bf16 v[64:79], v[48:51], v[96:99], v[64:79]
    ds_read_b32 v24, v25 offset:6464
    ds_read_b128 v[88:91], v8 offset:16384
    ds_read_b64_tr_b16 v[32:33], v16 offset:16384
    ds_read_b64_tr_b16 v[34:35], v16 offset:16896
    s_waitcnt lgkmcnt(10)
    v_mfma_f32_32x32x16_bf16 v[64:79], v[52:55], v[100:103], v[64:79]
    ds_read_b128 v[92:95], v9 offset:16384
    ds_read_b64_tr_b16 v[36:37], v16 offset:18432
    ds_read_b64_tr_b16 v[38:39], v16 offset:18944
    s_waitcnt lgkmcnt(10)
    v_mfma_f32_32x32x16_bf16 v[64:79], v[56:59], v[80:83], v[64:79]
    ds_read_b128 v[96:99], v10 offset:16384
    ds_read_b64_tr_b16 v[40:41], v16 offset:20480
    ds_read_b64_tr_b16 v[42:43], v16 offset:20992
    s_waitcnt lgkmcnt(10)
    v_mfma_f32_32x32x16_bf16 v[64:79], v[60:63], v[84:87], v[64:79]
    ds_read_b128 v[100:103], v11 offset:16384
    ds_read_b64_tr_b16 v[44:45], v16 offset:22528
    ds_read_b64_tr_b16 v[46:47], v16 offset:23040
    v_mov_b32 v28, 1
    s_mov_b64 exec, 1
    ds_write_b32 v29, v28 offset:16
    s_mov_b64 exec, -1
    s_waitcnt lgkmcnt(12)
    v_cmp_eq_u32 vcc, 0, v24
    s_cbranch_vccz L_qr_55x
L_qr_55:
    s_sub_u32 s90, s90, 1
    s_cbranch_scc1 L_exit_2
L_qr_55y:
    ds_read_b32 v24, v25 offset:6464
    s_waitcnt lgkmcnt(0)
    v_cmp_eq_u32 vcc, 0, v24
    s_cbranch_vccnz L_qr_55
    ds_read_b128 v[88:91], v8 offset:16384
    ds_read_b64_tr_b16 v[32:33], v16 offset:16384
    ds_read_b64_tr_b16 v[34:35], v16 offset:16896
    ds_read_b128 v[92:95], v9 offset:16384
    ds_read_b64_tr_b16 v[36:37], v16 offset:18432
    ds_read_b64_tr_b16 v[38:39], v16 offset:18944
    ds_read_b128 v[96:99], v10 offset:16384
    ds_read_b64_tr_b16 v[40:41], v16 offset:20480
    ds_read_b64_tr_b16 v[42:43], v16 offset:20992
    ds_read_b128 v[100:103], v11 offset:16384
    ds_read_b64_tr_b16 v[44:45], v16 offset:22528
    ds_read_b64_tr_b16 v[46:47], v16 offset:23040
L_qr_55x:
    s_waitcnt lgkmcnt(9)
    v_mfma_f32_32x32x16_bf16 v[64:79], v[32:35], v[88:91], v[64:79]
    ds_read_b128 v[80:83], v12 offset:16384
    ds_read_b64_tr_b16 v[48:49], v16 offset:24576
    ds_read_b64_tr_b16 v[50:51], v16 offset:25088
    s_waitcnt lgkmcnt(9)
    v_mfma_f32_32x32x16_bf16 v[64:79], v[36:39], v[92:95], v[64:79]
    ds_read_b128 v[84:87], v13 offset:16384
    ds_read_b64_tr_b16 v[52:53], v16 offset:26624
    ds_read_b64_tr_b16 v[54:55], v16 offset:27136
    s_waitcnt lgkmcnt(9)
    v_mfma_f32_32x32x16_bf16 v[64:79], v[40:43], v[96:99], v[64:79]
    ds_read_b128 v[88:91], v14 offset:16384
    ds_read_b64_tr_b16 v[56:57], v16 offset:28672
    ds_read_b64_tr_b16 v[58:59], v16 offset:29184
    s_waitcnt lgkmcnt(9)
    v_mfma_f32_32x32x16_bf16 v[64:79], v[44:47], v[100:103], v[64:79]
    ds_read_b128 v[92:95], v15 offset:16384
    ds_read_b64_tr_b16 v[60:61], v16 offset:30720
    ds_read_b64_tr_b16 v[62:63], v16 offset:31232
    s_waitcnt lgkmcnt(9)
    v_mfma_f32_32x32x16_bf16 v[64:79], v[48:51], v[80:83], v[64:79]
    ds_read_b32 v24, v25 offset:6496
    ds_read_b128 v[96:99], v8 offset:32768
    ds_read_b64_tr_b16 v[32:33], v16 offset:32768
    ds_read_b64_tr_b16 v[34:35], v16 offset:33280
    s_waitcnt lgkmcnt(10)
    v_mfma_f32_32x32x16_bf16 v[64:79], v[52:55], v[84:87], v[64:79]
    ds_read_b128 v[100:103], v9 offset:32768
    ds_read_b64_tr_b16 v[36:37], v16 offset:34816
    ds_read_b64_tr_b16 v[38:39], v16 offset:35328
    s_waitcnt lgkmcnt(10)
    v_mfma_f32_32x32x16_bf16 v[64:79], v[56:59], v[88:91], v[64:79]
    ds_read_b128 v[80:83], v10 offset:32768
    ds_read_b64_tr_b16 v[40:41], v16 offset:36864
    ds_read_b64_tr_b16 v[42:43], v16 offset:37376
    s_waitcnt lgkmcnt(10)
    v_mfma_f32_32x32x16_bf16 v[64:79], v[60:63], v[92:95], v[64:79]
    ds_read_b128 v[84:87], v11 offset:32768
    ds_read_b64_tr_b16 v[44:45], v16 offset:38912
    ds_read_b64_tr_b16 v[46:47], v16 offset:39424
    s_waitcnt lgkmcnt(12)
    v_cmp_eq_u32 vcc, 0, v24
    s_cbranch_vccz L_qr_56x
L_qr_56:
    s_sub_u32 s90, s90, 1
    s_cbranch_scc1 L_exit_2
L_qr_56y:
    ds_read_b32 v24, v25 offset:6496
    s_waitcnt lgkmcnt(0)
    v_cmp_eq_u32 vcc, 0, v24
    s_cbranch_vccnz L_qr_56
    ds_read_b128 v[96:99], v8 offset:32768
    ds_read_b64_tr_b16 v[32:33], v16 offset:32768
    ds_read_b64_tr_b16 v[34:35], v16 offset:33280
    ds_read_b128 v[100:103], v9 offset:32768
    ds_read_b64_tr_b16 v[36:37], v16 offset:34816
    ds_read_b64_tr_b16 v[38:39], v16 offset:35328
    ds_read_b128 v[80:83], v10 offset:32768
    ds_read_b64_tr_b16 v[40:41], v16 offset:36864
    ds_read_b64_tr_b16 v[42:43], v16 offset:37376
    ds_read_b128 v[84:87], v11 offset:32768
    ds_read_b64_tr_b16 v[44:45], v16 offset:38912
    ds_read_b64_tr_b16 v[46:47], v16 offset:39424
L_qr_56x:
    s_waitcnt lgkmcnt(9)
    v_mfma_f32_32x32x16_bf16 v[64:79], v[32:35], v[96:99], v[64:79]
    ds_read_b128 v[88:91], v12 offset:32768
    ds_read_b64_tr_b16 v[48:49], v16 offset:40960
    ds_read_b64_tr_b16 v[50:51], v16 offset:41472
    s_waitcnt lgkmcnt(9)
    v_mfma_f32_32x32x16_bf16 v[64:79], v[36:39], v[100:103], v[64:79]
    ds_read_b128 v[92:95], v13 offset:32768
    ds_read_b64_tr_b16 v[52:53], v16 offset:43008
    ds_read_b64_tr_b16 v[54:55], v16 offset:43520
    s_waitcnt lgkmcnt(9)
    v_mfma_f32_32x32x16_bf16 v[64:79], v[40:43], v[80:83], v[64:79]
    ds_read_b128 v[96:99], v14 offset:32768
    ds_read_b64_tr_b16 v[56:57], v16 offset:45056
    ds_read_b64_tr_b16 v[58:59], v16 offset:45568
    s_waitcnt lgkmcnt(9)
    v_mfma_f32_32x32x16_bf16 v[64:79], v[44:47], v[84:87], v[64:79]
    ds_read_b128 v[100:103], v15 offset:32768
    ds_read_b64_tr_b16 v[60:61], v16 offset:47104
    ds_read_b64_tr_b16 v[62:63], v16 offset:47616
    s_waitcnt lgkmcnt(9)
    v_mfma_f32_32x32x16_bf16 v[64:79], v[48:51], v[88:91], v[64:79]
    ds_read_b32 v24, v25 offset:6528
    ds_read_b128 v[80:83], v8 offset:49152
    ds_read_b64_tr_b16 v[32:33], v16 offset:49152
    ds_read_b64_tr_b16 v[34:35], v16 offset:49664
    s_waitcnt lgkmcnt(10)
    v_mfma_f32_32x32x16_bf16 v[64:79], v[52:55], v[92:95], v[64:79]
    ds_read_b128 v[84:87], v9 offset:49152
    ds_read_b64_tr_b16 v[36:37], v16 offset:51200
    ds_read_b64_tr_b16 v[38:39], v16 offset:51712
    s_waitcnt lgkmcnt(10)
    v_mfma_f32_32x32x16_bf16 v[64:79], v[56:59], v[96:99], v[64:79]
    ds_read_b128 v[88:91], v10 offset:49152
    ds_read_b64_tr_b16 v[40:41], v16 offset:53248
    ds_read_b64_tr_b16 v[42:43], v16 offset:53760
    s_waitcnt lgkmcnt(10)
    v_mfma_f32_32x32x16_bf16 v[64:79], v[60:63], v[100:103], v[64:79]
    ds_read_b128 v[92:95], v11 offset:49152
    ds_read_b64_tr_b16 v[44:45], v16 offset:55296
    ds_read_b64_tr_b16 v[46:47], v16 offset:55808
    s_waitcnt lgkmcnt(12)
    v_cmp_eq_u32 vcc, 0, v24
    s_cbranch_vccz L_qr_57x
L_qr_57:
    s_sub_u32 s90, s90, 1
    s_cbranch_scc1 L_exit_2
L_qr_57y:
    ds_read_b32 v24, v25 offset:6528
    s_waitcnt lgkmcnt(0)
    v_cmp_eq_u32 vcc, 0, v24
    s_cbranch_vccnz L_qr_57
    ds_read_b128 v[80:83], v8 offset:49152
    ds_read_b64_tr_b16 v[32:33], v16 offset:49152
    ds_read_b64_tr_b16 v[34:35], v16 offset:49664
    ds_read_b128 v[84:87], v9 offset:49152
    ds_read_b64_tr_b16 v[36:37], v16 offset:51200
    ds_read_b64_tr_b16 v[38:39], v16 offset:51712
    ds_read_b128 v[88:91], v10 offset:49152
    ds_read_b64_tr_b16 v[40:41], v16 offset:53248
    ds_read_b64_tr_b16 v[42:43], v16 offset:53760
    ds_read_b128 v[92:95], v11 offset:49152
    ds_read_b64_tr_b16 v[44:45], v16 offset:55296
    ds_read_b64_tr_b16 v[46:47], v16 offset:55808
L_qr_57x:
    s_waitcnt lgkmcnt(9)
    v_mfma_f32_32x32x16_bf16 v[64:79], v[32:35], v[80:83], v[64:79]
    ds_read_b128 v[96:99], v12 offset:49152
    ds_read_b64_tr_b16 v[48:49], v16 offset:57344
    ds_read_b64_tr_b16 v[50:51], v16 offset:57856
    s_waitcnt lgkmcnt(9)
    v_mfma_f32_32x32x16_bf16 v[64:79], v[36:39], v[84:87], v[64:79]
    ds_read_b128 v[100:103], v13 offset:49152
    ds_read_b64_tr_b16 v[52:53], v16 offset:59392
    ds_read_b64_tr_b16 v[54:55], v16 offset:59904
    s_waitcnt lgkmcnt(9)
    v_mfma_f32_32x32x16_bf16 v[64:79], v[40:43], v[88:91], v[64:79]
    ds_read_b128 v[80:83], v14 offset:49152
    ds_read_b64_tr_b16 v[56:57], v16 offset:61440
    ds_read_b64_tr_b16 v[58:59], v16 offset:61952
    s_waitcnt lgkmcnt(9)
    v_mfma_f32_32x32x16_bf16 v[64:79], v[44:47], v[92:95], v[64:79]
    ds_read_b128 v[84:87], v15 offset:49152
    ds_read_b64_tr_b16 v[60:61], v16 offset:63488
    ds_read_b64_tr_b16 v[62:63], v16 offset:64000
    s_waitcnt lgkmcnt(9)
    v_mfma_f32_32x32x16_bf16 v[64:79], v[48:51], v[96:99], v[64:79]
    s_waitcnt lgkmcnt(6)
    v_mfma_f32_32x32x16_bf16 v[64:79], v[52:55], v[100:103], v[64:79]
    s_waitcnt lgkmcnt(3)
    v_mfma_f32_32x32x16_bf16 v[64:79], v[56:59], v[80:83], v[64:79]
    s_waitcnt lgkmcnt(0)
    v_mfma_f32_32x32x16_bf16 v[64:79], v[60:63], v[84:87], v[64:79]
    v_mov_b32 v28, 4
    s_mov_b64 exec, 1
    ds_write_b32 v29, v28 offset:16
    s_mov_b64 exec, -1
    s_mov_b64 vcc, -1
    s_nop 4
    s_nop 7
    v_cvt_pk_bf16_f32 v32, v64, v65
    v_cvt_pk_bf16_f32 v33, v66, v67
    v_cvt_pk_bf16_f32 v34, v68, v69
    v_cvt_pk_bf16_f32 v35, v70, v71
    ds_write_b128 v17, v[32:35]
    v_cvt_pk_bf16_f32 v36, v72, v73
    v_cvt_pk_bf16_f32 v37, v74, v75
    v_cvt_pk_bf16_f32 v38, v76, v77
    v_cvt_pk_bf16_f32 v39, v78, v79
    ds_write_b128 v17, v[36:39] offset:17664
    v_mov_b32 v28, 5
    s_mov_b64 exec, 1
    ds_write_b32 v29, v28 offset:16
    s_mov_b64 exec, -1
    s_setprio 0
L_nq_46x:
    ds_read_b64 v[96:97], v30 offset:0
    ds_read_b64 v[98:99], v31 offset:16
    ds_read_b128 v[8:11], v1 offset:0
    ds_read_b128 v[24:27], v4
    ds_read_b128 v[16:19], v2 offset:0
    ds_read_b128 v[20:23], v2 offset:576
    s_waitcnt lgkmcnt(4)
    v_min_u32 v96, v96, v97
    v_min_u32 v98, v98, v99
    v_readfirstlane_b32 s38, v96
    v_readfirstlane_b32 s35, v98
    s_cmp_ge_u32 s38, 9
    s_cbranch_scc0 L_nq_46
    s_cmp_ge_u32 s35, 5
    s_cbranch_scc0 L_nq_46
L_nq_46y:
    s_waitcnt lgkmcnt(3)
    v_mfma_f32_32x32x16_bf16 v[40:55], v[8:11], v[32:35], 0
    v_mov_b32 v79, 0xdddddddd
    v_mov_b64 v[80:81], 0
    v_mov_b64 v[112:113], 0
    v_mov_b64 v[82:83], 0
    v_mov_b64 v[114:115], 0
    v_mov_b64 v[84:85], 0
    v_mov_b64 v[116:117], 0
    v_mov_b64 v[86:87], 0
    v_mov_b64 v[118:119], 0
    v_mov_b64 v[88:89], 0
    v_mov_b64 v[120:121], 0
    s_nop 0
    v_exp_f32 v40, v40
    v_exp_f32 v41, v41
    v_exp_f32 v42, v42
    s_branch L_loop_43e
L_loop_43:
    v_exp_f32 v40, v40
    v_exp_f32 v41, v41
    v_exp_f32 v42, v42
    v_smfmac_f32_32x32x32_bf16 v[80:95], v[132:135], v[64:71], v79
L_loop_43e:
    s_waitcnt lgkmcnt(0)
    ds_read_b128 v[12:15], v1 offset:2048
    v_exp_f32 v43, v43
    v_exp_f32 v44, v44
    v_mfma_f32_32x32x16_bf16 v[56:71], v[8:11], v[24:27], 0
    ds_read_b128 v[128:131], v2 offset:2304
    v_exp_f32 v45, v45
    v_exp_f32 v46, v46
    v_exp_f32 v47, v47
    v_exp_f32 v48, v48
    v_exp_f32 v49, v49
    v_smfmac_f32_32x32x32_bf16 v[80:95], v[16:19], v[40:47], v79
    ds_read_b128 v[132:135], v2 offset:2880
    v_exp_f32 v50, v50
    v_exp_f32 v51, v51
    v_exp_f32 v52, v52
    v_exp_f32 v53, v53
    v_exp_f32 v54, v54
    v_exp_f32 v55, v55
    v_exp_f32 v56, v56
    v_exp_f32 v57, v57
    v_exp_f32 v58, v58
    v_smfmac_f32_32x32x32_bf16 v[80:95], v[20:23], v[48:55], v79
    v_exp_f32 v59, v59
    v_exp_f32 v60, v60
    s_waitcnt lgkmcnt(2)
    v_mfma_f32_32x32x16_bf16 v[40:55], v[12:15], v[24:27], 0
    v_exp_f32 v61, v61
    v_exp_f32 v62, v62
    v_exp_f32 v63, v63
    v_exp_f32 v64, v64
    v_exp_f32 v65, v65
    v_smfmac_f32_32x32x32_bf16 v[112:127], v[16:19], v[56:63], v79
    v_exp_f32 v66, v66
    v_exp_f32 v67, v67
    v_exp_f32 v68, v68
    v_exp_f32 v69, v69
    v_exp_f32 v70, v70
    v_exp_f32 v71, v71
    s_cbranch_vccnz L_mc_58
L_mc_58r:
    v_exp_f32 v40, v40
    v_exp_f32 v41, v41
    v_exp_f32 v42, v42
    v_smfmac_f32_32x32x32_bf16 v[112:127], v[20:23], v[64:71], v79
    s_waitcnt lgkmcnt(0)
    ds_read_b128 v[8:11], v1 offset:4096
    v_exp_f32 v43, v43
    v_exp_f32 v44, v44
    v_mfma_f32_32x32x16_bf16 v[56:71], v[12:15], v[32:35], 0
    ds_read_b128 v[16:19], v2 offset:4608
    v_exp_f32 v45, v45
    v_exp_f32 v46, v46
    v_exp_f32 v47, v47
    v_exp_f32 v48, v48
    v_exp_f32 v49, v49
    v_smfmac_f32_32x32x32_bf16 v[112:127], v[128:131], v[40:47], v79
    ds_read_b128 v[20:23], v2 offset:5184
    v_exp_f32 v50, v50
    v_exp_f32 v51, v51
    v_exp_f32 v52, v52
    v_exp_f32 v53, v53
    v_exp_f32 v54, v54
    v_exp_f32 v55, v55
    v_exp_f32 v56, v56
    v_exp_f32 v57, v57
    v_exp_f32 v58, v58
    v_smfmac_f32_32x32x32_bf16 v[112:127], v[132:135], v[48:55], v79
    v_exp_f32 v59, v59
    v_exp_f32 v60, v60
    s_waitcnt lgkmcnt(2)
    v_mfma_f32_32x32x16_bf16 v[40:55], v[8:11], v[32:35], 0
    v_exp_f32 v61, v61
    v_exp_f32 v62, v62
    v_exp_f32 v63, v63
    v_exp_f32 v64, v64
    v_exp_f32 v65, v65
    v_smfmac_f32_32x32x32_bf16 v[80:95], v[128:131], v[56:63], v79
    v_exp_f32 v66, v66
    v_exp_f32 v67, v67
    v_exp_f32 v68, v68
    v_exp_f32 v69, v69
    v_exp_f32 v70, v70
    v_exp_f32 v71, v71
    v_exp_f32 v40, v40
    v_exp_f32 v41, v41
    v_exp_f32 v42, v42
    v_smfmac_f32_32x32x32_bf16 v[80:95], v[132:135], v[64:71], v79
    s_waitcnt lgkmcnt(0)
    ds_read_b128 v[12:15], v1 offset:6144
    v_exp_f32 v43, v43
    v_exp_f32 v44, v44
    v_mfma_f32_32x32x16_bf16 v[56:71], v[8:11], v[24:27], 0
    ds_read_b128 v[128:131], v2 offset:6912
    v_exp_f32 v45, v45
    v_exp_f32 v46, v46
    v_exp_f32 v47, v47
    v_exp_f32 v48, v48
    v_exp_f32 v49, v49
    v_smfmac_f32_32x32x32_bf16 v[80:95], v[16:19], v[40:47], v79
    ds_read_b128 v[132:135], v2 offset:7488
    v_exp_f32 v50, v50
    v_exp_f32 v51, v51
    v_exp_f32 v52, v52
    v_exp_f32 v53, v53
    v_exp_f32 v54, v54
    v_exp_f32 v55, v55
    v_exp_f32 v56, v56
    v_exp_f32 v57, v57
    v_exp_f32 v58, v58
    v_smfmac_f32_32x32x32_bf16 v[80:95], v[20:23], v[48:55], v79
    v_exp_f32 v59, v59
    v_exp_f32 v60, v60
    s_waitcnt lgkmcnt(2)
    v_mfma_f32_32x32x16_bf16 v[40:55], v[12:15], v[24:27], 0
    v_exp_f32 v61, v61
    v_exp_f32 v62, v62
    v_exp_f32 v63, v63
    v_exp_f32 v64, v64
    v_exp_f32 v65, v65
    v_smfmac_f32_32x32x32_bf16 v[112:127], v[16:19], v[56:63], v79
    v_exp_f32 v66, v66
    v_exp_f32 v67, v67
    v_exp_f32 v68, v68
    v_exp_f32 v69, v69
    v_exp_f32 v70, v70
    v_exp_f32 v71, v71
    v_exp_f32 v40, v40
    v_exp_f32 v41, v41
    v_exp_f32 v42, v42
    v_smfmac_f32_32x32x32_bf16 v[112:127], v[20:23], v[64:71], v79
    s_waitcnt lgkmcnt(0)
    ds_read_b128 v[8:11], v1 offset:8192
    v_exp_f32 v43, v43
    v_exp_f32 v44, v44
    v_mfma_f32_32x32x16_bf16 v[56:71], v[12:15], v[32:35], 0
    ds_read_b128 v[16:19], v2 offset:9216
    v_exp_f32 v45, v45
    v_exp_f32 v46, v46
    v_exp_f32 v47, v47
    v_exp_f32 v48, v48
    v_exp_f32 v49, v49
    v_smfmac_f32_32x32x32_bf16 v[112:127], v[128:131], v[40:47], v79
    ds_read_b128 v[20:23], v2 offset:9792
    v_exp_f32 v50, v50
    v_exp_f32 v51, v51
    v_exp_f32 v52, v52
    v_exp_f32 v53, v53
    v_exp_f32 v54, v54
    v_exp_f32 v55, v55
    v_exp_f32 v56, v56
    v_exp_f32 v57, v57
    v_exp_f32 v58, v58
    v_smfmac_f32_32x32x32_bf16 v[112:127], v[132:135], v[48:55], v79
    v_exp_f32 v59, v59
    v_exp_f32 v60, v60
    s_waitcnt lgkmcnt(2)
    v_mfma_f32_32x32x16_bf16 v[40:55], v[8:11], v[32:35], 0
    v_exp_f32 v61, v61
    v_exp_f32 v62, v62
    v_exp_f32 v63, v63
    v_exp_f32 v64, v64
    v_exp_f32 v65, v65
    v_smfmac_f32_32x32x32_bf16 v[80:95], v[128:131], v[56:63], v79
    v_exp_f32 v66, v66
    v_exp_f32 v67, v67
    v_exp_f32 v68, v68
    s_cmp_eq_u32 s34, 7
    s_cbranch_scc1 L_es_59
L_es_59r:
    v_exp_f32 v69, v69
    v_exp_f32 v70, v70
    v_exp_f32 v71, v71
    v_add_u32 v1, 0x2000, v1
    v_add_u32 v2, 0x2400, v2
    s_add_u32 s34, s34, 1
    s_cmp_eq_u32 s34, 8
    s_cbranch_scc1 L_epi_45
    s_add_u32 s39, s34, 10
    s_cmp_ge_u32 s38, s39
    s_cbranch_scc1 L_ok2_61
L_chk_60:
    ds_read_b64 v[96:97], v30 offset:0
    s_waitcnt lgkmcnt(0)
    v_min_u32 v96, v96, v97
    s_nop 0
    v_readfirstlane_b32 s38, v96
    s_cmp_ge_u32 s38, s39
    s_cbranch_scc1 L_ok2_61
    s_sleep 1
    s_sub_u32 s90, s90, 1
    s_cbranch_scc0 L_chk_60
    s_branch L_exit_2
L_ok2_61:
    s_bitcmp1_b32 s36, s34
    s_cbranch_scc0 L_loop_43
    s_cmp_lg_u32 s34, 1
    s_cbranch_scc1 L_prio_62y
    s_setprio 2
L_prio_62y:
    s_cmp_lg_u32 s34, s17
    s_cbranch_scc1 L_prio_62
    s_setprio 1
L_prio_62:
    s_cmp_lg_u32 s34, s18
    s_cbranch_scc1 L_p7_65
    s_setprio 0
L_p7_65:
    v_mov_b32 v96, s34
    s_mov_b64 exec, 1
    ds_write_b32 v29, v96 offset:176
    s_mov_b64 exec, -1
    s_cmp_eq_u32 s34, 6
    s_cbranch_scc1 L_g2_64
    s_cmp_eq_u32 s34, 7
    s_cbranch_scc0 L_loop_43
    ds_read_b128 v[108:111], v30 offset:176
    ds_read_b128 v[100:103], v30 offset:192
    s_lshl_b32 s35, s12, 11
    s_add_u32 s35, s35, 0x8000
    v_add_u32 v37, s35, v3
    s_lshl_b32 s35, s12, 8
    s_add_u32 s35, s35, 0x26600
    v_lshl_add_u32 v38, v0, 2, s35
    v_xor_b32 v39, 0x800, v37
    v_xor_b32 v28, 0x100, v38
    s_branch L_loop_43
L_g2_64:
    s_sub_u32 s90, s90, 1
    s_cbranch_scc1 L_exit_2
    ds_read_b32 v96, v30 offset:92
    v_lshlrev_b32 v100, 2, v5
    s_waitcnt lgkmcnt(0)
    v_readfirstlane_b32 s35, v96
    s_cmp_eq_u32 s35, 1
    s_cbranch_scc0 L_g2_64
    buffer_load_dword v36, v100, s[24:27], s16 offen sc1
    s_branch L_loop_43
L_mc_58:
    s_mov_b64 vcc, 0
    s_cmp_ge_u32 s38, 10
    s_cbranch_scc1 L_mc_58r
    ds_read_b64 v[96:97], v30 offset:0
    s_waitcnt lgkmcnt(0)
    v_min_u32 v96, v96, v97
    s_sub_u32 s90, s90, 1
    v_readfirstlane_b32 s38, v96
    s_cbranch_scc0 L_mc_58
    s_branch L_exit_2
L_xb_68:
    s_sleep 1
    s_sub_u32 s90, s90, 1
    s_cbranch_scc1 L_exit_2
    ds_read_b128 v[108:111], v30 offset:176
    ds_read_b128 v[100:103], v30 offset:192
    s_waitcnt lgkmcnt(0)
    s_branch L_xa_67
L_xr_69:
    s_sleep 1
    s_sub_u32 s90, s90, 1
    s_cbranch_scc0 L_xr_69x
    s_branch L_exit_2
L_es_59:
    v_min3_u32 v108, v108, v109, v110
    v_min3_u32 v100, v100, v101, v102
    v_min3_u32 v108, v108, v111, v103
    v_min_u32 v108, v108, v100
    v_mov_b32 v96, 6
    v_readfirstlane_b32 s35, v108
    s_cmp_ge_u32 s35, s42
    s_cbranch_scc0 L_es_59r
    ds_write_b128 v37, v[112:115]
    ds_write_b128 v37, v[116:119] offset:1024
    ds_write_b32 v38, v120
    s_mov_b64 exec, 1
    ds_write_b32 v29, v96 offset:16
    s_mov_b64 exec, -1
    s_mov_b32 s42, 0
    s_branch L_es_59r
L_epi_45:
    s_setprio 3
    v_smfmac_f32_32x32x32_bf16 v[80:95], v[132:135], v[64:71], v79
    s_cmp_eq_u32 s42, 0
    s_cbranch_scc1 L_xr_69x
L_xa_67:
    v_min3_u32 v108, v108, v109, v110
    v_min3_u32 v100, v100, v101, v102
    v_min3_u32 v108, v108, v111, v103
    v_min_u32 v108, v108, v100
    v_mov_b32 v96, 6
    v_readfirstlane_b32 s35, v108
    s_cmp_ge_u32 s35, s42
    s_cbranch_scc0 L_xb_68
    ds_write_b128 v37, v[112:115]
    ds_write_b128 v37, v[116:119] offset:1024
    ds_write_b32 v38, v120
    s_mov_b64 exec, 1
    ds_write_b32 v29, v96 offset:16
    s_mov_b64 exec, -1
L_xr_69x:
    ds_read_b64 v[98:99], v31 offset:16
    ds_read_b128 v[40:43], v39
    ds_read_b128 v[44:47], v39 offset:1024
    ds_read_b32 v48, v28
    s_waitcnt lgkmcnt(3)
    v_min_u32 v98, v98, v99
    s_nop 0
    v_readfirstlane_b32 s35, v98
    s_cmp_ge_u32 s35, 6
    s_cbranch_scc0 L_xr_69
    s_waitcnt vmcnt(0) lgkmcnt(2)
    v_mov_b32 v4, v36
    v_add_f32 v80, v80, v40
    v_add_f32 v81, v81, v41
    v_add_f32 v82, v82, v42
    v_add_f32 v83, v83, v43
    s_waitcnt lgkmcnt(0)
    v_add_f32 v84, v84, v44
    v_add_f32 v85, v85, v45
    v_add_f32 v86, v86, v46
    v_add_f32 v87, v87, v47
    v_add_f32 v88, v88, v48
L_fin_63:
    v_mov_b32 v7, 0x30800000
    s_cmp_lg_u32 s33, 0
    v_fma_f32 v48, v80, 0, v88
    v_mul_f32 v49, 0, v81
    v_fma_f32 v48, v82, 0, v48
    v_fma_f32 v49, v83, 0, v49
    v_fma_f32 v48, v84, 0, v48
    v_fma_f32 v49, v85, 0, v49
    v_fma_f32 v48, v86, 0, v48
    v_fma_f32 v49, v87, 0, v49
    v_add_f32 v48, v48, v49
    s_nop 0
    v_mov_b32 v49, v48
    s_nop 1
    v_permlane32_swap_b32 v48, v49
    s_nop 0
    v_add_f32 v48, v48, v49
    s_cbranch_scc1 L_ok_66
    v_fma_f32 v49, v48, 0, v48
    v_cmp_nge_f32 vcc, v49, v7
    s_cbranch_vccnz L_fb_44
L_ok_66:
    v_rcp_f32 v48, v48
    s_nop 0
    v_mul_f32 v48, v4, v48
    v_mul_f32 v40, v48, v80
    v_mul_f32 v41, v48, v81
    v_mul_f32 v42, v48, v82
    v_mul_f32 v43, v48, v83
    v_mul_f32 v44, v48, v84
    v_mul_f32 v45, v48, v85
    v_mul_f32 v46, v48, v86
    v_mul_f32 v47, v48, v87
    v_cvt_pk_bf16_f32 v72, v40, v41
    v_cvt_pk_bf16_f32 v73, v42, v43
    v_cvt_pk_bf16_f32 v74, v44, v45
    v_cvt_pk_bf16_f32 v75, v46, v47
    v_min_u32 v72, -2, v72
    v_min_u32 v73, -2, v73
    v_min_u32 v74, -2, v74
    v_min_u32 v75, -2, v75
    v_mov_b32 v96, 8
    buffer_store_dwordx4 v[72:75], v3, s[24:27], s14 offen sc1
    s_mov_b64 exec, 1
    ds_write_b32 v29, v96 offset:176
    s_mov_b64 exec, -1
    v_bfe_u32 v24, v0, 4, 1
    v_bfe_u32 v25, v0, 2, 2
    v_and_b32 v26, 3, v0
    v_lshl_add_u32 v25, v6, 3, v25
    v_lshlrev_b32 v25, 6, v25
    v_lshl_add_u32 v25, v24, 5, v25
    v_lshl_add_u32 v25, v26, 3, v25
    s_lshr_b32 s38, s12, 1
    s_lshl_b32 s38, s38, 13
    v_add_u32 v25, s38, v25
    s_lshl_b32 s35, s12, 12
    s_add_u32 s35, s35, 0xc000
    v_add_u32 v26, s35, v3
    v_mov_b32 v97, 9
    s_waitcnt vmcnt(0)
    s_mov_b64 exec, 1
    ds_write_b32 v29, v97 offset:176
    s_mov_b64 exec, -1
    s_setprio 0
    v_mov_b32 v96, 7
L_yw_70:
    s_sub_u32 s90, s90, 1
    s_cbranch_scc1 L_exit_2
L_yw_70x:
    ds_read_b128 v[16:19], v30 offset:208
    s_waitcnt lgkmcnt(0)
    v_and_b32 v16, v16, v17
    v_and_b32 v18, v18, v19
    v_and_b32 v16, v16, v18
    s_nop 0
    v_readfirstlane_b32 s35, v16
    s_cmp_eq_u32 s35, 1
    s_cbranch_scc0 L_yw_70
    s_cmp_ge_u32 s12, 4
    s_cbranch_scc1 L_yq_72
    v_mov_b64 v[112:113], 0
    v_mov_b64 v[114:115], 0
    v_mov_b64 v[116:117], 0
    v_mov_b64 v[118:119], 0
    v_mov_b64 v[120:121], 0
    v_mov_b64 v[122:123], 0
    v_mov_b64 v[124:125], 0
    v_mov_b64 v[126:127], 0
    ds_read_b64_tr_b16 v[40:41], v25 offset:0
    ds_read_b64_tr_b16 v[42:43], v25 offset:256
    ds_read_b64_tr_b16 v[44:45], v25 offset:1024
    ds_read_b64_tr_b16 v[46:47], v25 offset:1280
    ds_read_b64_tr_b16 v[48:49], v25 offset:2048
    ds_read_b64_tr_b16 v[50:51], v25 offset:2304
    ds_read_b64_tr_b16 v[52:53], v25 offset:3072
    ds_read_b64_tr_b16 v[54:55], v25 offset:3328
    s_branch L_ym_73
L_yq_72:
    s_sub_u32 s90, s90, 1
    s_cbranch_scc1 L_exit_2
    ds_read_b32 v16, v29 offset:0
    ds_read_b128 v[112:115], v26 offset:0
    ds_read_b128 v[116:119], v26 offset:1024
    ds_read_b128 v[120:123], v26 offset:2048
    ds_read_b128 v[124:127], v26 offset:3072
    ds_read_b64_tr_b16 v[40:41], v25 offset:0
    ds_read_b64_tr_b16 v[42:43], v25 offset:256
    ds_read_b64_tr_b16 v[44:45], v25 offset:1024
    ds_read_b64_tr_b16 v[46:47], v25 offset:1280
    ds_read_b64_tr_b16 v[48:49], v25 offset:2048
    ds_read_b64_tr_b16 v[50:51], v25 offset:2304
    ds_read_b64_tr_b16 v[52:53], v25 offset:3072
    ds_read_b64_tr_b16 v[54:55], v25 offset:3328
    s_waitcnt lgkmcnt(12)
    v_readfirstlane_b32 s35, v16
    s_cmp_eq_u32 s35, 7
    s_cbranch_scc1 L_ym_73
    s_waitcnt lgkmcnt(0)
    s_branch L_yq_72
L_ym_73:
    s_waitcnt lgkmcnt(6)
    ds_read_b64_tr_b16 v[56:57], v25 offset:4096
    ds_read_b64_tr_b16 v[58:59], v25 offset:4352
    v_mfma_f32_32x32x16_bf16 v[112:127], v[136:139], v[40:43], v[112:127]
    s_waitcnt lgkmcnt(6)
    ds_read_b64_tr_b16 v[60:61], v25 offset:5120
    ds_read_b64_tr_b16 v[62:63], v25 offset:5376
    v_mfma_f32_32x32x16_bf16 v[112:127], v[140:143], v[44:47], v[112:127]
    s_waitcnt lgkmcnt(6)
    ds_read_b64_tr_b16 v[64:65], v25 offset:6144
    ds_read_b64_tr_b16 v[66:67], v25 offset:6400
    v_mfma_f32_32x32x16_bf16 v[112:127], v[144:147], v[48:51], v[112:127]
    s_waitcnt lgkmcnt(6)
    ds_read_b64_tr_b16 v[68:69], v25 offset:7168
    ds_read_b64_tr_b16 v[70:71], v25 offset:7424
    v_mfma_f32_32x32x16_bf16 v[112:127], v[148:151], v[52:55], v[112:127]
    s_waitcnt lgkmcnt(6)
    v_mfma_f32_32x32x16_bf16 v[112:127], v[152:155], v[56:59], v[112:127]
    s_waitcnt lgkmcnt(4)
    v_mfma_f32_32x32x16_bf16 v[112:127], v[156:159], v[60:63], v[112:127]
    s_waitcnt lgkmcnt(2)
    v_mfma_f32_32x32x16_bf16 v[112:127], v[164:167], v[64:67], v[112:127]
    s_waitcnt lgkmcnt(0)
    v_mfma_f32_32x32x16_bf16 v[112:127], v[160:163], v[68:71], v[112:127]
    s_nop 7
    s_nop 3
    ds_write_b128 v26, v[112:115] offset:16384
    ds_write_b128 v26, v[116:119] offset:17408
    ds_write_b128 v26, v[120:123] offset:18432
    ds_write_b128 v26, v[124:127] offset:19456
    s_mov_b64 exec, 1
    ds_write_b32 v29, v96 offset:16
    s_mov_b64 exec, -1
    s_waitcnt lgkmcnt(0)
    s_branch L_end_1
L_fb_44:
    v_lshlrev_b32 v1, 5, v5
    v_lshl_add_u32 v1, v6, 4, v1
    v_mov_b32 v7, 0xff7fffff
    s_mov_b32 s34, 0x200000
    s_mov_b32 s33, 1
L_fbl_74:
    buffer_load_dwordx4 v[8:11], v1, s[24:27], s34 offen sc1
    s_add_u32 s34, s34, 0x400
    s_cmp_lt_u32 s34, 0x210000
    s_waitcnt vmcnt(0)
    v_mfma_f32_32x32x16_bf16 v[40:55], v[8:11], v[32:35], 0
    s_nop 7
    s_nop 3
    v_max3_f32 v7, v40, v41, v7
    v_max3_f32 v7, v42, v43, v7
    v_max3_f32 v7, v44, v45, v7
    v_max3_f32 v7, v46, v47, v7
    v_max3_f32 v7, v48, v49, v7
    v_max3_f32 v7, v50, v51, v7
    v_max3_f32 v7, v52, v53, v7
    v_max3_f32 v7, v54, v55, v7
    s_cbranch_scc1 L_fbl_74
    v_mov_b32 v40, v7
    s_nop 1
    v_permlane32_swap_b32 v40, v7
    s_nop 0
    v_max_f32 v7, v40, v7
    v_sub_f32 v56, 0, v7
    v_subrev_u32 v2, s41, v2
    v_mov_b32 v57, v56
    s_mov_b32 s34, 0x200000
    s_mov_b32 s35, 0x228000
    v_mov_b64 v[58:59], v[56:57]
    v_mov_b64 v[60:61], v[56:57]
    v_mov_b64 v[62:63], v[56:57]
    v_mov_b64 v[64:65], v[56:57]
    v_mov_b64 v[66:67], v[56:57]
    v_mov_b64 v[68:69], v[56:57]
    v_mov_b64 v[70:71], v[56:57]
    v_mov_b64 v[80:81], 0
    v_mov_b64 v[82:83], 0
    v_mov_b64 v[84:85], 0
    v_mov_b64 v[86:87], 0
    v_mov_b64 v[88:89], 0
    v_mov_b64 v[90:91], 0
    v_mov_b64 v[92:93], 0
    v_mov_b64 v[94:95], 0
L_slow_75:
    buffer_load_dwordx4 v[8:11], v1, s[24:27], s34 offen sc1
    buffer_load_dwordx4 v[16:19], v2, s[24:27], s35 offen sc1
    buffer_load_dwordx4 v[20:23], v2, s[24:27], s35 offen offset:576 sc1
    s_add_u32 s34, s34, 0x400
    s_add_u32 s35, s35, 0x480
    s_cmp_lt_u32 s34, 0x210000
    s_waitcnt vmcnt(0)
    v_mfma_f32_32x32x16_bf16 v[40:55], v[8:11], v[32:35], v[56:71]
    s_nop 7
    s_nop 3
    v_exp_f32 v40, v40
    v_exp_f32 v41, v41
    v_exp_f32 v42, v42
    v_exp_f32 v43, v43
    v_exp_f32 v44, v44
    v_exp_f32 v45, v45
    v_exp_f32 v46, v46
    v_exp_f32 v47, v47
    v_exp_f32 v48, v48
    v_exp_f32 v49, v49
    v_exp_f32 v50, v50
    v_exp_f32 v51, v51
    v_exp_f32 v52, v52
    v_exp_f32 v53, v53
    v_exp_f32 v54, v54
    v_exp_f32 v55, v55
    s_nop 2
    v_smfmac_f32_32x32x32_bf16 v[80:95], v[16:19], v[40:47], v79
    v_smfmac_f32_32x32x32_bf16 v[80:95], v[20:23], v[48:55], v79
    s_nop 7
    s_cbranch_scc1 L_slow_75
    s_nop 7
    s_branch L_fin_63
L_fft_6:
L_fft_6x:
    s_and_b32 s38, s2, 7
    s_lshl_b32 s38, s38, 5
    s_lshr_b32 s39, s2, 3
    s_add_u32 s38, s38, s39
    s_sub_u32 s13, s12, 8
    s_lshl_b32 s29, s38, 13
    s_add_u32 s29, s29, 0x300000
    s_lshl_b32 s31, s13, 11
    s_add_u32 s31, s31, 0x71a000
    v_mov_b32 v7, v156
    v_mov_b32 v5, 1
    v_lshl_add_u32 v4, s13, 2, v155
    s_lshl_b32 s3, s13, 13
    s_add_u32 s3, s3, 0x712000
    s_add_u32 s16, s3, 4096
    s_lshl_b32 s18, s38, 13
    s_lshl_b32 s34, s13, 11
    s_add_u32 s18, s18, s34
    s_add_u32 s18, s18, 0x500000
    s_mov_b32 s30, 0x710000
    s_mov_b32 s23, 0x711000
    s_and_b32 s39, s2, 7
    s_lshl_b32 s39, s39, 13
    s_lshl_b32 s34, s13, 11
    s_add_u32 s39, s39, s34
    s_add_u32 s39, s39, 0x740000
    s_branch L_fg_76x
L_fg_76:
    s_sleep 16
    s_sub_u32 s90, s90, 1
    s_cbranch_scc1 L_exit_2
L_fg_76x:
    ds_read_b32 v164, v7 offset:8
    ds_read_b32 v2, v155 offset:6400
    s_waitcnt lgkmcnt(0)
    v_readfirstlane_b32 s35, v164
    s_cmpk_eq_u32 s35, 100
    s_cbranch_scc0 L_fg_76
    buffer_load_dwordx4 v[72:75], v145, s[24:27], s29 offen sc1
    buffer_load_dwordx4 v[76:79], v145, s[24:27], s29 offen offset:64 sc1
    buffer_load_dwordx4 v[8:11], v3, s[24:27], s30 offen offset:0 sc1
    buffer_load_dwordx4 v[12:15], v3, s[24:27], s30 offen offset:1024 sc1
    buffer_load_dwordx4 v[16:19], v3, s[24:27], s30 offen offset:2048 sc1
    buffer_load_dwordx4 v[20:23], v3, s[24:27], s30 offen offset:3072 sc1
    buffer_load_dwordx4 v[24:27], v3, s[24:27], s23 offen offset:0 sc1
    buffer_load_dwordx4 v[28:31], v3, s[24:27], s23 offen offset:1024 sc1
    buffer_load_dwordx4 v[32:35], v3, s[24:27], s23 offen offset:2048 sc1
    buffer_load_dwordx4 v[36:39], v3, s[24:27], s23 offen offset:3072 sc1
    buffer_load_dwordx4 v[120:123], v3, s[24:27], s31 offen offset:0 sc1
    buffer_load_dwordx4 v[128:131], v3, s[24:27], s31 offen offset:1024 sc1
    buffer_load_dwordx4 v[40:43], v3, s[24:27], s3 offen offset:0 sc1
    buffer_load_dwordx4 v[44:47], v3, s[24:27], s3 offen offset:1024 sc1
    buffer_load_dwordx4 v[48:51], v3, s[24:27], s3 offen offset:2048 sc1
    buffer_load_dwordx4 v[52:55], v3, s[24:27], s3 offen offset:3072 sc1
    buffer_load_dwordx4 v[56:59], v3, s[24:27], s16 offen offset:0 sc1
    buffer_load_dwordx4 v[60:63], v3, s[24:27], s16 offen offset:1024 sc1
    buffer_load_dwordx4 v[64:67], v3, s[24:27], s16 offen offset:2048 sc1
    buffer_load_dwordx4 v[68:71], v3, s[24:27], s16 offen offset:3072 sc1
    buffer_load_dword v1, v154, s[24:27], s39 offen sc1
    s_waitcnt vmcnt(9)
    v_mfma_f32_16x16x32_bf16 v[104:107], v[8:11], v[72:75], 0
    v_mfma_f32_16x16x32_bf16 v[108:111], v[16:19], v[72:75], 0
    v_mfma_f32_16x16x32_bf16 v[104:107], v[12:15], v[76:79], v[104:107]
    v_mfma_f32_16x16x32_bf16 v[108:111], v[20:23], v[76:79], v[108:111]
    v_mfma_f32_16x16x32_bf16 v[112:115], v[24:27], v[72:75], 0
    v_mfma_f32_16x16x32_bf16 v[116:119], v[32:35], v[72:75], 0
    v_mfma_f32_16x16x32_bf16 v[112:115], v[28:31], v[76:79], v[112:115]
    v_mfma_f32_16x16x32_bf16 v[116:119], v[36:39], v[76:79], v[116:119]
    s_nop 3
    v_fma_mix_f32 v80, v104, v120, 0 op_sel_hi:[0,1,0]
    v_fma_mix_f32 v84, v108, v120, 0 op_sel_hi:[0,1,0]
    v_fma_mix_f32 v81, v105, v121, 0 op_sel_hi:[0,1,0]
    v_fma_mix_f32 v85, v109, v121, 0 op_sel_hi:[0,1,0]
    v_fma_mix_f32 v82, v106, v122, 0 op_sel_hi:[0,1,0]
    v_fma_mix_f32 v86, v110, v122, 0 op_sel_hi:[0,1,0]
    v_fma_mix_f32 v83, v107, v123, 0 op_sel_hi:[0,1,0]
    v_fma_mix_f32 v87, v111, v123, 0 op_sel_hi:[0,1,0]
    v_fma_mix_f32 v80, v108, v120, v80 op_sel:[0,1,0] op_sel_hi:[0,1,0]
    v_fma_mix_f32 v84, -v104, v120, v84 op_sel:[0,1,0] op_sel_hi:[0,1,0]
    v_fma_mix_f32 v81, v109, v121, v81 op_sel:[0,1,0] op_sel_hi:[0,1,0]
    v_fma_mix_f32 v85, -v105, v121, v85 op_sel:[0,1,0] op_sel_hi:[0,1,0]
    v_fma_mix_f32 v82, v110, v122, v82 op_sel:[0,1,0] op_sel_hi:[0,1,0]
    v_fma_mix_f32 v86, -v106, v122, v86 op_sel:[0,1,0] op_sel_hi:[0,1,0]
    v_fma_mix_f32 v83, v111, v123, v83 op_sel:[0,1,0] op_sel_hi:[0,1,0]
    v_fma_mix_f32 v87, -v107, v123, v87 op_sel:[0,1,0] op_sel_hi:[0,1,0]
    v_cvt_pk_bf16_f32 v96, v80, v84
    v_cvt_pk_bf16_f32 v97, v81, v85
    v_cvt_pk_bf16_f32 v98, v82, v86
    v_cvt_pk_bf16_f32 v99, v83, v87
    ds_write_b32 v146, v96 offset:0
    ds_write_b32 v146, v97 offset:272
    ds_write_b32 v146, v98 offset:544
    ds_write_b32 v146, v99 offset:816
    v_fma_mix_f32 v88, v112, v128, 0 op_sel_hi:[0,1,0]
    v_fma_mix_f32 v92, v116, v128, 0 op_sel_hi:[0,1,0]
    v_fma_mix_f32 v89, v113, v129, 0 op_sel_hi:[0,1,0]
    v_fma_mix_f32 v93, v117, v129, 0 op_sel_hi:[0,1,0]
    v_fma_mix_f32 v90, v114, v130, 0 op_sel_hi:[0,1,0]
    v_fma_mix_f32 v94, v118, v130, 0 op_sel_hi:[0,1,0]
    v_fma_mix_f32 v91, v115, v131, 0 op_sel_hi:[0,1,0]
    v_fma_mix_f32 v95, v119, v131, 0 op_sel_hi:[0,1,0]
    v_fma_mix_f32 v88, v116, v128, v88 op_sel:[0,1,0] op_sel_hi:[0,1,0]
    v_fma_mix_f32 v92, -v112, v128, v92 op_sel:[0,1,0] op_sel_hi:[0,1,0]
    v_fma_mix_f32 v89, v117, v129, v89 op_sel:[0,1,0] op_sel_hi:[0,1,0]
    v_fma_mix_f32 v93, -v113, v129, v93 op_sel:[0,1,0] op_sel_hi:[0,1,0]
    v_fma_mix_f32 v90, v118, v130, v90 op_sel:[0,1,0] op_sel_hi:[0,1,0]
    v_fma_mix_f32 v94, -v114, v130, v94 op_sel:[0,1,0] op_sel_hi:[0,1,0]
    v_fma_mix_f32 v91, v119, v131, v91 op_sel:[0,1,0] op_sel_hi:[0,1,0]
    v_fma_mix_f32 v95, -v115, v131, v95 op_sel:[0,1,0] op_sel_hi:[0,1,0]
    v_cvt_pk_bf16_f32 v100, v88, v92
    v_cvt_pk_bf16_f32 v101, v89, v93
    v_cvt_pk_bf16_f32 v102, v90, v94
    v_cvt_pk_bf16_f32 v103, v91, v95
    ds_write_b32 v146, v100 offset:4352
    ds_write_b32 v146, v101 offset:4624
    ds_write_b32 v146, v102 offset:4896
    ds_write_b32 v146, v103 offset:5168
    s_mov_b64 exec, 1
    ds_write_b32 v4, v5 offset:80
    s_mov_b64 exec, -1
    s_add_u32 s31, s31, 0x2000
    buffer_load_dwordx4 v[120:123], v3, s[24:27], s31 offen offset:0 sc1
    buffer_load_dwordx4 v[128:131], v3, s[24:27], s31 offen offset:1024 sc1
    s_mov_b32 s34, 0
    s_waitcnt vmcnt(2)
L_wp_79:
    v_cmp_ne_u32 vcc, v1, v2
    s_cbranch_vccz L_wq_80
    s_sleep 2
    buffer_load_dword v1, v154, s[24:27], s39 offen sc1
    s_add_u32 s34, s34, 1
    s_cmp_lt_u32 s34, 0x20000
    s_waitcnt vmcnt(0)
    s_cbranch_scc1 L_wp_79
L_wq_80:
    buffer_load_dwordx4 v[136:139], v160, s[24:27], s18 offen offset:0 sc1
    buffer_load_dwordx4 v[140:143], v160, s[24:27], s18 offen offset:16 sc1
    s_cmp_lg_u32 s2, 0
    s_cbranch_scc1 L_nw_78
    s_lshl_b32 s18, s13, 13
    s_add_u32 s18, s18, 0x708000
    s_add_u32 s34, s18, 4096
    buffer_load_dwordx4 v[8:11], v3, s[24:27], s18 offen offset:0 sc1
    buffer_load_dwordx4 v[12:15], v3, s[24:27], s18 offen offset:1024 sc1
    buffer_load_dwordx4 v[16:19], v3, s[24:27], s18 offen offset:2048 sc1
    buffer_load_dwordx4 v[20:23], v3, s[24:27], s18 offen offset:3072 sc1
    buffer_load_dwordx4 v[24:27], v3, s[24:27], s34 offen offset:0 sc1
    buffer_load_dwordx4 v[28:31], v3, s[24:27], s34 offen offset:1024 sc1
    buffer_load_dwordx4 v[32:35], v3, s[24:27], s34 offen offset:2048 sc1
    buffer_load_dwordx4 v[36:39], v3, s[24:27], s34 offen offset:3072 sc1
L_nw_78:
L_sy_81:
    ds_read_b32 v164, v7 offset:80
    s_waitcnt lgkmcnt(0)
    v_cmp_gt_u32 vcc, 1, v164
    s_cbranch_vccz L_sz_82
    s_sleep 8
    s_sub_u32 s90, s90, 1
    s_cbranch_scc0 L_sy_81
    s_branch L_exit_2
L_sz_82:
    ds_read_b128 v[72:75], v147 offset:0
    ds_read_b128 v[76:79], v147 offset:64
    ds_read_b128 v[80:83], v147 offset:128
    ds_read_b128 v[84:87], v147 offset:192
    ds_read_b128 v[88:91], v147 offset:4352
    ds_read_b128 v[92:95], v147 offset:4416
    ds_read_b128 v[96:99], v147 offset:4480
    ds_read_b128 v[100:103], v147 offset:4544
    s_waitcnt lgkmcnt(7)
    v_mfma_f32_16x16x32_bf16 v[104:107], v[40:43], v[72:75], 0
    v_mfma_f32_16x16x32_bf16 v[108:111], v[56:59], v[72:75], 0
    s_waitcnt lgkmcnt(6)
    v_mfma_f32_16x16x32_bf16 v[104:107], v[44:47], v[76:79], v[104:107]
    v_mfma_f32_16x16x32_bf16 v[108:111], v[60:63], v[76:79], v[108:111]
    s_waitcnt lgkmcnt(5)
    v_mfma_f32_16x16x32_bf16 v[104:107], v[48:51], v[80:83], v[104:107]
    v_mfma_f32_16x16x32_bf16 v[108:111], v[64:67], v[80:83], v[108:111]
    s_waitcnt lgkmcnt(4)
    v_mfma_f32_16x16x32_bf16 v[104:107], v[52:55], v[84:87], v[104:107]
    v_mfma_f32_16x16x32_bf16 v[108:111], v[68:71], v[84:87], v[108:111]
    s_waitcnt lgkmcnt(3)
    v_mfma_f32_16x16x32_bf16 v[112:115], v[40:43], v[88:91], 0
    v_mfma_f32_16x16x32_bf16 v[116:119], v[56:59], v[88:91], 0
    s_waitcnt lgkmcnt(2)
    v_mfma_f32_16x16x32_bf16 v[112:115], v[44:47], v[92:95], v[112:115]
    v_mfma_f32_16x16x32_bf16 v[116:119], v[60:63], v[92:95], v[116:119]
    s_waitcnt lgkmcnt(1)
    v_mfma_f32_16x16x32_bf16 v[112:115], v[48:51], v[96:99], v[112:115]
    v_mfma_f32_16x16x32_bf16 v[116:119], v[64:67], v[96:99], v[116:119]
    s_waitcnt lgkmcnt(0)
    v_mfma_f32_16x16x32_bf16 v[112:115], v[52:55], v[100:103], v[112:115]
    v_mfma_f32_16x16x32_bf16 v[116:119], v[68:71], v[100:103], v[116:119]
    s_cmp_eq_u32 s2, 0
    s_cbranch_scc1 L_z0_83
    s_waitcnt vmcnt(0)
    v_lshlrev_b32 v72, 16, v136
    v_and_b32 v76, 0xffff0000, v136
    v_lshlrev_b32 v73, 16, v137
    v_and_b32 v77, 0xffff0000, v137
    v_lshlrev_b32 v74, 16, v138
    v_and_b32 v78, 0xffff0000, v138
    v_lshlrev_b32 v75, 16, v139
    v_and_b32 v79, 0xffff0000, v139
    v_lshlrev_b32 v88, 16, v140
    v_and_b32 v92, 0xffff0000, v140
    v_lshlrev_b32 v89, 16, v141
    v_and_b32 v93, 0xffff0000, v141
    v_lshlrev_b32 v90, 16, v142
    v_and_b32 v94, 0xffff0000, v142
    v_lshlrev_b32 v91, 16, v143
    v_and_b32 v95, 0xffff0000, v143
    v_pk_mul_f32 v[80:81], v[104:105], v[72:73]
    v_pk_mul_f32 v[84:85], v[108:109], v[72:73]
    v_pk_fma_f32 v[80:81], v[108:109], v[76:77], v[80:81] neg_lo:[1,0,0] neg_hi:[1,0,0]
    v_pk_fma_f32 v[84:85], v[104:105], v[76:77], v[84:85]
    v_pk_mul_f32 v[82:83], v[106:107], v[74:75]
    v_pk_mul_f32 v[86:87], v[110:111], v[74:75]
    v_pk_fma_f32 v[82:83], v[110:111], v[78:79], v[82:83] neg_lo:[1,0,0] neg_hi:[1,0,0]
    v_pk_fma_f32 v[86:87], v[106:107], v[78:79], v[86:87]
    v_pk_mul_f32 v[96:97], v[112:113], v[88:89]
    v_pk_mul_f32 v[100:101], v[116:117], v[88:89]
    v_pk_fma_f32 v[96:97], v[116:117], v[92:93], v[96:97] neg_lo:[1,0,0] neg_hi:[1,0,0]
    v_pk_fma_f32 v[100:101], v[112:113], v[92:93], v[100:101]
    v_pk_mul_f32 v[98:99], v[114:115], v[90:91]
    v_pk_mul_f32 v[102:103], v[118:119], v[90:91]
    v_pk_fma_f32 v[98:99], v[118:119], v[94:95], v[98:99] neg_lo:[1,0,0] neg_hi:[1,0,0]
    v_pk_fma_f32 v[102:103], v[114:115], v[94:95], v[102:103]
L_zr_84:
    v_cvt_pk_bf16_f32 v72, v84, v80
    v_cvt_pk_bf16_f32 v73, v85, v81
    v_cvt_pk_bf16_f32 v74, v86, v82
    v_cvt_pk_bf16_f32 v75, v87, v83
    ds_write_b128 v149, v[72:75] offset:0
    v_cvt_pk_bf16_f32 v88, v100, v96
    v_cvt_pk_bf16_f32 v89, v101, v97
    v_cvt_pk_bf16_f32 v90, v102, v98
    v_cvt_pk_bf16_f32 v91, v103, v99
    ds_write_b128 v149, v[88:91] offset:4096
    s_mov_b64 exec, 1
    ds_write_b32 v4, v5 offset:96
    s_mov_b64 exec, -1
L_sy_85:
    ds_read_b32 v164, v7 offset:96
    s_waitcnt lgkmcnt(0)
    v_cmp_gt_u32 vcc, 1, v164
    s_cbranch_vccz L_sz_86
    s_sleep 8
    s_sub_u32 s90, s90, 1
    s_cbranch_scc0 L_sy_85
    s_branch L_exit_2
L_sz_86:
    ds_read_b128 v[72:75], v148 offset:0
    ds_read_b128 v[76:79], v148 offset:1024
    ds_read_b128 v[80:83], v148 offset:2048
    ds_read_b128 v[84:87], v148 offset:3072
    ds_read_b128 v[88:91], v148 offset:4096
    ds_read_b128 v[92:95], v148 offset:5120
    ds_read_b128 v[96:99], v148 offset:6144
    ds_read_b128 v[100:103], v148 offset:7168
    s_waitcnt lgkmcnt(7)
    v_mfma_f32_16x16x32_bf16 v[104:107], v[40:43], v[72:75], 0
    v_mfma_f32_16x16x32_bf16 v[108:111], v[56:59], v[72:75], 0
    s_waitcnt lgkmcnt(6)
    v_mfma_f32_16x16x32_bf16 v[104:107], v[44:47], v[76:79], v[104:107]
    v_mfma_f32_16x16x32_bf16 v[108:111], v[60:63], v[76:79], v[108:111]
    s_waitcnt lgkmcnt(5)
    v_mfma_f32_16x16x32_bf16 v[104:107], v[48:51], v[80:83], v[104:107]
    v_mfma_f32_16x16x32_bf16 v[108:111], v[64:67], v[80:83], v[108:111]
    s_waitcnt lgkmcnt(4)
    v_mfma_f32_16x16x32_bf16 v[104:107], v[52:55], v[84:87], v[104:107]
    v_mfma_f32_16x16x32_bf16 v[108:111], v[68:71], v[84:87], v[108:111]
    s_waitcnt lgkmcnt(3)
    v_mfma_f32_16x16x32_bf16 v[112:115], v[40:43], v[88:91], 0
    v_mfma_f32_16x16x32_bf16 v[116:119], v[56:59], v[88:91], 0
    s_waitcnt lgkmcnt(2)
    v_mfma_f32_16x16x32_bf16 v[112:115], v[44:47], v[92:95], v[112:115]
    v_mfma_f32_16x16x32_bf16 v[116:119], v[60:63], v[92:95], v[116:119]
    s_waitcnt lgkmcnt(1)
    v_mfma_f32_16x16x32_bf16 v[112:115], v[48:51], v[96:99], v[112:115]
    v_mfma_f32_16x16x32_bf16 v[116:119], v[64:67], v[96:99], v[116:119]
    s_waitcnt lgkmcnt(0)
    v_mfma_f32_16x16x32_bf16 v[112:115], v[52:55], v[100:103], v[112:115]
    v_mfma_f32_16x16x32_bf16 v[116:119], v[68:71], v[100:103], v[116:119]
    s_waitcnt vmcnt(0)
    v_fma_mix_f32 v72, v108, v120, 0 op_sel_hi:[0,1,0]
    v_fma_mix_f32 v76, v104, v120, 0 op_sel_hi:[0,1,0]
    v_fma_mix_f32 v73, v109, v121, 0 op_sel_hi:[0,1,0]
    v_fma_mix_f32 v77, v105, v121, 0 op_sel_hi:[0,1,0]
    v_fma_mix_f32 v74, v110, v122, 0 op_sel_hi:[0,1,0]
    v_fma_mix_f32 v78, v106, v122, 0 op_sel_hi:[0,1,0]
    v_fma_mix_f32 v75, v111, v123, 0 op_sel_hi:[0,1,0]
    v_fma_mix_f32 v79, v107, v123, 0 op_sel_hi:[0,1,0]
    v_fma_mix_f32 v72, -v104, v120, v72 op_sel:[0,1,0] op_sel_hi:[0,1,0]
    v_fma_mix_f32 v76, v108, v120, v76 op_sel:[0,1,0] op_sel_hi:[0,1,0]
    v_fma_mix_f32 v73, -v105, v121, v73 op_sel:[0,1,0] op_sel_hi:[0,1,0]
    v_fma_mix_f32 v77, v109, v121, v77 op_sel:[0,1,0] op_sel_hi:[0,1,0]
    v_fma_mix_f32 v74, -v106, v122, v74 op_sel:[0,1,0] op_sel_hi:[0,1,0]
    v_fma_mix_f32 v78, v110, v122, v78 op_sel:[0,1,0] op_sel_hi:[0,1,0]
    v_fma_mix_f32 v75, -v107, v123, v75 op_sel:[0,1,0] op_sel_hi:[0,1,0]
    v_fma_mix_f32 v79, v111, v123, v79 op_sel:[0,1,0] op_sel_hi:[0,1,0]
    v_cvt_pk_bf16_f32 v80, v76, v72
    v_cvt_pk_bf16_f32 v81, v77, v73
    v_cvt_pk_bf16_f32 v82, v78, v74
    v_cvt_pk_bf16_f32 v83, v79, v75
    ds_write_b32 v150, v80 offset:0
    ds_write_b32 v150, v81 offset:144
    ds_write_b32 v150, v82 offset:288
    ds_write_b32 v150, v83 offset:432
    v_fma_mix_f32 v88, v116, v128, 0 op_sel_hi:[0,1,0]
    v_fma_mix_f32 v92, v112, v128, 0 op_sel_hi:[0,1,0]
    v_fma_mix_f32 v89, v117, v129, 0 op_sel_hi:[0,1,0]
    v_fma_mix_f32 v93, v113, v129, 0 op_sel_hi:[0,1,0]
    v_fma_mix_f32 v90, v118, v130, 0 op_sel_hi:[0,1,0]
    v_fma_mix_f32 v94, v114, v130, 0 op_sel_hi:[0,1,0]
    v_fma_mix_f32 v91, v119, v131, 0 op_sel_hi:[0,1,0]
    v_fma_mix_f32 v95, v115, v131, 0 op_sel_hi:[0,1,0]
    v_fma_mix_f32 v88, -v112, v128, v88 op_sel:[0,1,0] op_sel_hi:[0,1,0]
    v_fma_mix_f32 v92, v116, v128, v92 op_sel:[0,1,0] op_sel_hi:[0,1,0]
    v_fma_mix_f32 v89, -v113, v129, v89 op_sel:[0,1,0] op_sel_hi:[0,1,0]
    v_fma_mix_f32 v93, v117, v129, v93 op_sel:[0,1,0] op_sel_hi:[0,1,0]
    v_fma_mix_f32 v90, -v114, v130, v90 op_sel:[0,1,0] op_sel_hi:[0,1,0]
    v_fma_mix_f32 v94, v118, v130, v94 op_sel:[0,1,0] op_sel_hi:[0,1,0]
    v_fma_mix_f32 v91, -v115, v131, v91 op_sel:[0,1,0] op_sel_hi:[0,1,0]
    v_fma_mix_f32 v95, v119, v131, v95 op_sel:[0,1,0] op_sel_hi:[0,1,0]
    v_cvt_pk_bf16_f32 v96, v92, v88
    v_cvt_pk_bf16_f32 v97, v93, v89
    v_cvt_pk_bf16_f32 v98, v94, v90
    v_cvt_pk_bf16_f32 v99, v95, v91
    ds_write_b32 v150, v96 offset:64
    ds_write_b32 v150, v97 offset:208
    ds_write_b32 v150, v98 offset:352
    ds_write_b32 v150, v99 offset:496
    s_mov_b64 exec, 1
    ds_write_b32 v4, v5 offset:112
    s_mov_b64 exec, -1
L_sy_87:
    ds_read_b32 v164, v7 offset:112
    s_waitcnt lgkmcnt(0)
    v_cmp_gt_u32 vcc, 1, v164
    s_cbranch_vccz L_sz_88
    s_sleep 8
    s_sub_u32 s90, s90, 1
    s_cbranch_scc0 L_sy_87
    s_branch L_exit_2
L_sz_88:
    ds_read_b128 v[72:75], v151
    ds_read_b128 v[76:79], v151 offset:64
    s_lshl_b32 s3, s38, 12
    s_add_u32 s3, s3, 0xa00000
    s_add_u32 s16, s3, 0x100000
    s_waitcnt lgkmcnt(0)
    v_mfma_f32_16x16x32_bf16 v[104:107], v[8:11], v[72:75], 0
    v_mfma_f32_16x16x32_bf16 v[108:111], v[16:19], v[72:75], 0
    v_mfma_f32_16x16x32_bf16 v[104:107], v[12:15], v[76:79], v[104:107]
    v_mfma_f32_16x16x32_bf16 v[108:111], v[20:23], v[76:79], v[108:111]
    v_mfma_f32_16x16x32_bf16 v[112:115], v[24:27], v[72:75], 0
    v_mfma_f32_16x16x32_bf16 v[116:119], v[32:35], v[72:75], 0
    v_mfma_f32_16x16x32_bf16 v[112:115], v[28:31], v[76:79], v[112:115]
    v_mfma_f32_16x16x32_bf16 v[116:119], v[36:39], v[76:79], v[116:119]
    s_nop 4
    v_cvt_pk_bf16_f32 v80, v108, v109
    v_cvt_pk_bf16_f32 v81, v110, v111
    v_cvt_pk_bf16_f32 v84, v104, v105
    v_cvt_pk_bf16_f32 v85, v106, v107
    v_cvt_pk_bf16_f32 v82, v116, v117
    v_cvt_pk_bf16_f32 v83, v118, v119
    v_cvt_pk_bf16_f32 v86, v112, v113
    v_cvt_pk_bf16_f32 v87, v114, v115
    v_permlane16_swap_b32 v80, v82
    v_permlane16_swap_b32 v81, v83
    v_permlane16_swap_b32 v84, v86
    v_permlane16_swap_b32 v85, v87
    buffer_store_dwordx4 v[80:83], v153, s[24:27], s3 offen sc1
    buffer_store_dwordx4 v[84:87], v153, s[24:27], s16 offen sc1
L_nof_77:
    s_load_dwordx2 s[80:81], s[0:1], 72
    s_lshr_b32 s34, s51, 1
    s_lshl_b32 s35, s34, 1
    s_and_b32 s62, s13, 1
    s_add_u32 s35, s35, s62
    s_lshr_b32 s63, s13, 1
    s_lshl_b32 s34, s63, 3
    s_add_u32 s35, s35, s34
    s_lshl_b32 s37, s35, 15
    s_add_u32 s37, s37, 0xc00000
    s_lshl_b32 s58, s35, 6
    s_and_b32 s59, s51, 1
    s_lshl_b32 s60, s50, 1
    s_add_u32 s60, s60, s59
    s_waitcnt vmcnt(0)
    s_mov_b32 s39, s37
    s_cmp_lg_u32 s12, 10
    s_cbranch_scc1 L_nk_89
    s_mov_b64 exec, 1
    ds_write_b32 v4, v5 offset:224
    s_mov_b64 exec, -1
L_sy_92:
    ds_read_b32 v164, v7 offset:224
    s_waitcnt lgkmcnt(0)
    v_cmp_gt_u32 vcc, 1, v164
    s_cbranch_vccz L_sz_93
    s_sleep 1
    s_sub_u32 s90, s90, 1
    s_cbranch_scc0 L_sy_92
    s_branch L_exit_2
L_sz_93:
    v_mov_b32 v152, s55
    v_mov_b32 v153, s55
    v_mov_b32 v154, s55
    v_mov_b32 v155, s55
    v_lshrrev_b32 v160, 1, v0
    v_lshlrev_b32 v160, 13, v160
    v_and_b32 v161, 1, v0
    v_lshl_add_u32 v160, v161, 4, v160
    s_mov_b64 exec, 65535
    s_add_u32 s36, s53, 131072
    buffer_store_dwordx4 v[152:155], v160, s[24:27], s36 offen sc1
    s_mov_b64 exec, -1
    v_mov_b32 v156, 2
    v_lshlrev_b32 v161, 5, v0
    s_mov_b64 exec, 1
    ds_write_b32 v4, v156 offset:224
    s_mov_b64 exec, -1
    s_mov_b32 s34, 0
    s_add_u32 s64, s54, 131072
    s_mov_b64 s[68:69], -1
    s_add_u32 s65, s54, 133120
    s_mov_b64 s[70:71], -1
    s_add_u32 s66, s54, 135168
    s_mov_b64 s[72:73], -1
    s_add_u32 s67, s54, 137216
    s_mov_b64 s[74:75], -1
L_gp_96:
    s_mov_b64 exec, s[68:69]
    buffer_load_dword v156, v161, s[24:27], s64 offen sc1
    s_mov_b64 exec, s[70:71]
    buffer_load_dword v157, v161, s[24:27], s65 offen sc1
    s_mov_b64 exec, s[72:73]
    buffer_load_dword v158, v161, s[24:27], s66 offen sc1
    s_mov_b64 exec, s[74:75]
    buffer_load_dword v159, v161, s[24:27], s67 offen sc1
    s_add_u32 s34, s34, 1
    s_waitcnt vmcnt(0)
    s_mov_b64 exec, s[68:69]
    v_cmp_ne_u32 s[68:69], v156, v152
    s_mov_b64 exec, s[70:71]
    v_cmp_ne_u32 s[70:71], v157, v152
    s_mov_b64 exec, s[72:73]
    v_cmp_ne_u32 s[72:73], v158, v152
    s_mov_b64 exec, s[74:75]
    v_cmp_ne_u32 s[74:75], v159, v152
    s_nop 0
    s_or_b64 s[76:77], s[68:69], s[70:71]
    s_or_b64 s[76:77], s[76:77], s[72:73]
    s_or_b64 s[76:77], s[76:77], s[74:75]
    s_cbranch_scc0 L_gq_97
    s_sleep 2
    s_cmp_lt_u32 s34, 0x20000
    s_cbranch_scc1 L_gp_96
L_gq_97:
    s_mov_b64 exec, 1
    ds_write_b32 v7, v5 offset:72
    s_mov_b64 exec, -1
    s_branch L_nk2_94
L_nk_89:
    s_mov_b64 exec, 1
    ds_write_b32 v4, v5 offset:224
    s_mov_b64 exec, -1
    s_cmp_eq_u32 s2, 0
    s_cbranch_scc1 L_nk2_94
L_k6_95:
    s_sleep 8
    s_sub_u32 s90, s90, 1
    s_cbranch_scc1 L_exit_2
    ds_read_b32 v164, v7 offset:232
    s_waitcnt lgkmcnt(0)
    v_readfirstlane_b32 s35, v164
    s_cmp_eq_u32 s35, 2
    s_cbranch_scc0 L_k6_95
    buffer_load_dwordx4 v[8:11], v3, s[24:27], s37 offen offset:0 sc1
    buffer_load_dwordx4 v[12:15], v3, s[24:27], s37 offen offset:1024 sc1
    buffer_load_dwordx4 v[16:19], v3, s[24:27], s37 offen offset:2048 sc1
    buffer_load_dwordx4 v[20:23], v3, s[24:27], s37 offen offset:3072 sc1
    s_add_u32 s37, s37, 0x1000
    buffer_load_dwordx4 v[24:27], v3, s[24:27], s37 offen offset:0 sc1
    buffer_load_dwordx4 v[28:31], v3, s[24:27], s37 offen offset:1024 sc1
    buffer_load_dwordx4 v[32:35], v3, s[24:27], s37 offen offset:2048 sc1
    buffer_load_dwordx4 v[36:39], v3, s[24:27], s37 offen offset:3072 sc1
    s_add_u32 s37, s37, 0x1000
    buffer_load_dwordx4 v[40:43], v3, s[24:27], s37 offen offset:0 sc1
    buffer_load_dwordx4 v[44:47], v3, s[24:27], s37 offen offset:1024 sc1
    buffer_load_dwordx4 v[48:51], v3, s[24:27], s37 offen offset:2048 sc1
    buffer_load_dwordx4 v[52:55], v3, s[24:27], s37 offen offset:3072 sc1
    s_add_u32 s37, s37, 0x1000
    buffer_load_dwordx4 v[56:59], v3, s[24:27], s37 offen offset:0 sc1
    buffer_load_dwordx4 v[60:63], v3, s[24:27], s37 offen offset:1024 sc1
    buffer_load_dwordx4 v[64:67], v3, s[24:27], s37 offen offset:2048 sc1
    buffer_load_dwordx4 v[68:71], v3, s[24:27], s37 offen offset:3072 sc1
    s_add_u32 s37, s37, 0x1000
    buffer_load_dwordx4 v[72:75], v3, s[24:27], s37 offen offset:0 sc1
    buffer_load_dwordx4 v[76:79], v3, s[24:27], s37 offen offset:1024 sc1
    buffer_load_dwordx4 v[80:83], v3, s[24:27], s37 offen offset:2048 sc1
    buffer_load_dwordx4 v[84:87], v3, s[24:27], s37 offen offset:3072 sc1
    s_add_u32 s37, s37, 0x1000
    buffer_load_dwordx4 v[88:91], v3, s[24:27], s37 offen offset:0 sc1
    buffer_load_dwordx4 v[92:95], v3, s[24:27], s37 offen offset:1024 sc1
    buffer_load_dwordx4 v[96:99], v3, s[24:27], s37 offen offset:2048 sc1
    buffer_load_dwordx4 v[100:103], v3, s[24:27], s37 offen offset:3072 sc1
    s_add_u32 s37, s37, 0x1000
    buffer_load_dwordx4 v[104:107], v3, s[24:27], s37 offen offset:0 sc1
    buffer_load_dwordx4 v[108:111], v3, s[24:27], s37 offen offset:1024 sc1
    buffer_load_dwordx4 v[112:115], v3, s[24:27], s37 offen offset:2048 sc1
    buffer_load_dwordx4 v[116:119], v3, s[24:27], s37 offen offset:3072 sc1
    s_add_u32 s37, s37, 0x1000
    buffer_load_dwordx4 v[120:123], v3, s[24:27], s37 offen offset:0 sc1
    buffer_load_dwordx4 v[124:127], v3, s[24:27], s37 offen offset:1024 sc1
    buffer_load_dwordx4 v[128:131], v3, s[24:27], s37 offen offset:2048 sc1
    buffer_load_dwordx4 v[132:135], v3, s[24:27], s37 offen offset:3072 sc1
L_nk2_94:
    v_lshrrev_b32 v1, 2, v0
    v_and_b32 v2, 3, v0
    v_lshlrev_b32 v1, 13, v1
    v_lshl_add_u32 v1, v2, 4, v1
    s_lshl_b32 s36, s63, 20
    s_lshl_b32 s38, s62, 12
    s_add_u32 s36, s36, s38
    s_lshl_b32 s38, s60, 6
    s_add_u32 s36, s36, s38
    s_add_u32 s36, s36, 0xa00000
    s_lshl_b32 s38, s13, 13
    s_branch L_w3_90x
L_w3_90:
    s_sleep 8
    s_sub_u32 s90, s90, 1
    s_cbranch_scc1 L_exit_2
L_w3_90x:
    ds_read_b32 v154, v7 offset:72
    ds_read_b32 v152, v7 offset:176
    ds_read_b32 v153, v7 offset:192
    s_waitcnt lgkmcnt(0)
    v_readfirstlane_b32 s35, v154
    s_cmp_ge_u32 s35, 1
    s_cbranch_scc0 L_w3_90
    v_min_u32 v152, v152, v153
    v_cmp_gt_u32 vcc, 4, v152
    s_cbranch_vccnz L_w3_90
    s_add_u32 m0, s38, 0
    s_nop 0
    buffer_load_dwordx4 v1, s[24:27], s36 offen sc1 lds
    s_add_u32 s36, s36, 0x20000
    s_add_u32 m0, s38, 1024
    s_nop 0
    buffer_load_dwordx4 v1, s[24:27], s36 offen sc1 lds
    s_add_u32 s36, s36, 0x20000
    s_add_u32 m0, s38, 2048
    s_nop 0
    buffer_load_dwordx4 v1, s[24:27], s36 offen sc1 lds
    s_add_u32 s36, s36, 0x20000
    s_add_u32 m0, s38, 3072
    s_nop 0
    buffer_load_dwordx4 v1, s[24:27], s36 offen sc1 lds
    s_add_u32 s36, s36, 0x20000
    s_add_u32 m0, s38, 4096
    s_nop 0
    buffer_load_dwordx4 v1, s[24:27], s36 offen sc1 lds
    s_add_u32 s36, s36, 0x20000
    s_add_u32 m0, s38, 5120
    s_nop 0
    buffer_load_dwordx4 v1, s[24:27], s36 offen sc1 lds
    s_add_u32 s36, s36, 0x20000
    s_add_u32 m0, s38, 6144
    s_nop 0
    buffer_load_dwordx4 v1, s[24:27], s36 offen sc1 lds
    s_add_u32 s36, s36, 0x20000
    s_add_u32 m0, s38, 7168
    s_nop 0
    buffer_load_dwordx4 v1, s[24:27], s36 offen sc1 lds
    s_add_u32 s36, s36, 0x20000
    s_lshl_b32 s36, s60, 15
    s_lshl_b32 s38, s13, 13
    s_add_u32 s36, s36, s38
    s_add_u32 s36, s36, 0x800000
    s_add_u32 s37, s36, 0x1000
    s_lshl_b32 s38, s13, 12
    v_add_u32 v2, 0x22000, v3
    v_add_u32 v1, s38, v2
    v_add_u32 v6, s38, v3
    s_mov_b32 s82, 0x200000
    s_mov_b32 s83, 0x00020000
    s_lshl_b32 s61, s60, 10
    s_add_u32 s61, s61, s58
    s_waitcnt vmcnt(0)
    s_mov_b64 exec, 1
    ds_write_b32 v4, v5 offset:208
    s_mov_b64 exec, -1
    s_cmp_eq_u32 s2, 0
    s_cselect_b32 s35, 10, s12
    s_cmp_lg_u32 s35, 10
    s_cbranch_scc1 L_nk3_98
    buffer_load_dwordx4 v[8:11], v3, s[24:27], s39 offen offset:0 sc1
    buffer_load_dwordx4 v[12:15], v3, s[24:27], s39 offen offset:1024 sc1
    buffer_load_dwordx4 v[16:19], v3, s[24:27], s39 offen offset:2048 sc1
    buffer_load_dwordx4 v[20:23], v3, s[24:27], s39 offen offset:3072 sc1
    s_add_u32 s39, s39, 0x1000
    buffer_load_dwordx4 v[24:27], v3, s[24:27], s39 offen offset:0 sc1
    buffer_load_dwordx4 v[28:31], v3, s[24:27], s39 offen offset:1024 sc1
    buffer_load_dwordx4 v[32:35], v3, s[24:27], s39 offen offset:2048 sc1
    buffer_load_dwordx4 v[36:39], v3, s[24:27], s39 offen offset:3072 sc1
    s_add_u32 s39, s39, 0x1000
    buffer_load_dwordx4 v[40:43], v3, s[24:27], s39 offen offset:0 sc1
    buffer_load_dwordx4 v[44:47], v3, s[24:27], s39 offen offset:1024 sc1
    buffer_load_dwordx4 v[48:51], v3, s[24:27], s39 offen offset:2048 sc1
    buffer_load_dwordx4 v[52:55], v3, s[24:27], s39 offen offset:3072 sc1
    s_add_u32 s39, s39, 0x1000
    buffer_load_dwordx4 v[56:59], v3, s[24:27], s39 offen offset:0 sc1
    buffer_load_dwordx4 v[60:63], v3, s[24:27], s39 offen offset:1024 sc1
    buffer_load_dwordx4 v[64:67], v3, s[24:27], s39 offen offset:2048 sc1
    buffer_load_dwordx4 v[68:71], v3, s[24:27], s39 offen offset:3072 sc1
    s_add_u32 s39, s39, 0x1000
    buffer_load_dwordx4 v[72:75], v3, s[24:27], s39 offen offset:0 sc1
    buffer_load_dwordx4 v[76:79], v3, s[24:27], s39 offen offset:1024 sc1
    buffer_load_dwordx4 v[80:83], v3, s[24:27], s39 offen offset:2048 sc1
    buffer_load_dwordx4 v[84:87], v3, s[24:27], s39 offen offset:3072 sc1
    s_add_u32 s39, s39, 0x1000
    buffer_load_dwordx4 v[88:91], v3, s[24:27], s39 offen offset:0 sc1
    buffer_load_dwordx4 v[92:95], v3, s[24:27], s39 offen offset:1024 sc1
    buffer_load_dwordx4 v[96:99], v3, s[24:27], s39 offen offset:2048 sc1
    buffer_load_dwordx4 v[100:103], v3, s[24:27], s39 offen offset:3072 sc1
    s_add_u32 s39, s39, 0x1000
    buffer_load_dwordx4 v[104:107], v3, s[24:27], s39 offen offset:0 sc1
    buffer_load_dwordx4 v[108:111], v3, s[24:27], s39 offen offset:1024 sc1
    buffer_load_dwordx4 v[112:115], v3, s[24:27], s39 offen offset:2048 sc1
    buffer_load_dwordx4 v[116:119], v3, s[24:27], s39 offen offset:3072 sc1
    s_add_u32 s39, s39, 0x1000
    buffer_load_dwordx4 v[120:123], v3, s[24:27], s39 offen offset:0 sc1
    buffer_load_dwordx4 v[124:127], v3, s[24:27], s39 offen offset:1024 sc1
    buffer_load_dwordx4 v[128:131], v3, s[24:27], s39 offen offset:2048 sc1
    buffer_load_dwordx4 v[132:135], v3, s[24:27], s39 offen offset:3072 sc1
L_nk3_98:
L_wa_99:
    s_sleep 4
    s_sub_u32 s90, s90, 1
    s_cbranch_scc1 L_exit_2
    ds_read_b32 v152, v7 offset:176
    s_waitcnt lgkmcnt(0)
    v_cmp_gt_u32 vcc, 9, v152
    s_cbranch_vccnz L_wa_99
    s_mov_b32 s34, 0
L_og_100:
    buffer_load_dwordx4 v[136:139], v3, s[24:27], s36 offen offset:1024 sc1
    buffer_load_dwordx4 v[140:143], v3, s[24:27], s36 offen offset:3072 sc1
    buffer_load_dwordx4 v[144:147], v3, s[24:27], s37 offen offset:1024 sc1
    buffer_load_dwordx4 v[148:151], v3, s[24:27], s37 offen offset:3072 sc1
    s_add_u32 s34, s34, 1
    s_waitcnt vmcnt(3)
    ds_write_b128 v1, v[136:139] offset:0
    v_max3_u32 v152, v136, v137, v138
    v_max_u32 v152, v152, v139
    s_waitcnt vmcnt(2)
    ds_write_b128 v1, v[140:143] offset:1024
    v_max3_u32 v153, v140, v141, v142
    v_max_u32 v153, v153, v143
    s_waitcnt vmcnt(1)
    ds_write_b128 v1, v[144:147] offset:2048
    v_max3_u32 v154, v144, v145, v146
    v_max_u32 v154, v154, v147
    s_waitcnt vmcnt(0)
    ds_write_b128 v1, v[148:151] offset:3072
    v_max3_u32 v155, v148, v149, v150
    v_max_u32 v155, v155, v151
    v_max3_u32 v152, v152, v153, v154
    v_max_u32 v152, v152, v155
    v_cmp_eq_u32 vcc, -1, v152
    s_cbranch_vccz L_oh_101
    s_cmp_lt_u32 s34, 0x20000
    s_cbranch_scc1 L_og_100
L_oh_101:
    s_mov_b32 s65, 9
    s_lshl_b32 s66, s60, 7
    s_add_u32 s66, s66, 0x220000
    s_mov_b64 exec, 1
    ds_write_b32 v4, v5 offset:240
    s_mov_b64 exec, -1
L_sy_102:
    ds_read_b32 v164, v7 offset:240
    s_waitcnt lgkmcnt(0)
    v_cmp_gt_u32 vcc, 1, v164
    s_cbranch_vccz L_sz_103
    s_sub_u32 s90, s90, 1
    s_cbranch_scc0 L_sy_102
    s_branch L_exit_2
L_sz_103:
    ds_read_b128 v[152:155], v2 offset:0
    ds_read_b128 v[156:159], v2 offset:1024
    ds_read_b128 v[164:167], v2 offset:2048
    ds_read_b128 v[160:163], v2 offset:3072
    s_waitcnt lgkmcnt(3)
    v_mfma_f32_32x32x16_bf16 v[136:151], v[12:15], v[152:155], 0
    ds_read_b128 v[152:155], v2 offset:4096
    s_waitcnt lgkmcnt(3)
    v_mfma_f32_32x32x16_bf16 v[136:151], v[20:23], v[156:159], v[136:151]
    ds_read_b128 v[156:159], v2 offset:5120
    s_waitcnt lgkmcnt(3)
    v_mfma_f32_32x32x16_bf16 v[136:151], v[28:31], v[164:167], v[136:151]
    ds_read_b128 v[164:167], v2 offset:6144
    s_waitcnt lgkmcnt(3)
    v_mfma_f32_32x32x16_bf16 v[136:151], v[36:39], v[160:163], v[136:151]
    ds_read_b128 v[160:163], v2 offset:7168
    s_waitcnt lgkmcnt(3)
    v_mfma_f32_32x32x16_bf16 v[136:151], v[44:47], v[152:155], v[136:151]
    ds_read_b32 v44, v7 offset:192
    ds_read_b128 v[152:155], v2 offset:8192
    s_waitcnt lgkmcnt(4)
    v_mfma_f32_32x32x16_bf16 v[136:151], v[52:55], v[156:159], v[136:151]
    ds_read_b128 v[156:159], v2 offset:9216
    s_waitcnt lgkmcnt(4)
    v_mfma_f32_32x32x16_bf16 v[136:151], v[60:63], v[164:167], v[136:151]
    v_lshlrev_b32 v52, 2, v0
    v_and_b32 v52, 0x7c, v52
    buffer_load_dword v52, v52, s[24:27], s66 offen sc1
    s_waitcnt lgkmcnt(2)
    v_cmp_gt_u32 vcc, s65, v44
    s_cbranch_vccnz L_eg_104
    buffer_load_dwordx4 v[12:15], v3, s[24:27], s36 offen offset:0 sc1
    buffer_load_dwordx4 v[20:23], v3, s[24:27], s36 offen offset:2048 sc1
    buffer_load_dwordx4 v[28:31], v3, s[24:27], s37 offen offset:0 sc1
    buffer_load_dwordx4 v[36:39], v3, s[24:27], s37 offen offset:2048 sc1
    s_mov_b32 s65, -1
L_eg_104:
    ds_read_b128 v[164:167], v2 offset:10240
    s_waitcnt lgkmcnt(4)
    v_mfma_f32_32x32x16_bf16 v[136:151], v[68:71], v[160:163], v[136:151]
    ds_read_b32 v44, v7 offset:192
    ds_read_b128 v[160:163], v2 offset:11264
    s_waitcnt lgkmcnt(4)
    v_mfma_f32_32x32x16_bf16 v[136:151], v[76:79], v[152:155], v[136:151]
    ds_read_b128 v[152:155], v2 offset:12288
    s_waitcnt lgkmcnt(4)
    v_mfma_f32_32x32x16_bf16 v[136:151], v[84:87], v[156:159], v[136:151]
    s_waitcnt lgkmcnt(2)
    v_cmp_gt_u32 vcc, s65, v44
    s_cbranch_vccnz L_eg_105
    buffer_load_dwordx4 v[12:15], v3, s[24:27], s36 offen offset:0 sc1
    buffer_load_dwordx4 v[20:23], v3, s[24:27], s36 offen offset:2048 sc1
    buffer_load_dwordx4 v[28:31], v3, s[24:27], s37 offen offset:0 sc1
    buffer_load_dwordx4 v[36:39], v3, s[24:27], s37 offen offset:2048 sc1
    s_mov_b32 s65, -1
L_eg_105:
    ds_read_b128 v[156:159], v2 offset:13312
    s_waitcnt lgkmcnt(4)
    v_mfma_f32_32x32x16_bf16 v[136:151], v[92:95], v[164:167], v[136:151]
    ds_read_b32 v44, v7 offset:192
    ds_read_b128 v[164:167], v2 offset:14336
    s_waitcnt lgkmcnt(4)
    v_mfma_f32_32x32x16_bf16 v[136:151], v[100:103], v[160:163], v[136:151]
    ds_read_b128 v[160:163], v2 offset:15360
    s_waitcnt lgkmcnt(4)
    v_mfma_f32_32x32x16_bf16 v[136:151], v[108:111], v[152:155], v[136:151]
    s_waitcnt lgkmcnt(2)
    v_cmp_gt_u32 vcc, s65, v44
    s_cbranch_vccnz L_eg_106
    buffer_load_dwordx4 v[12:15], v3, s[24:27], s36 offen offset:0 sc1
    buffer_load_dwordx4 v[20:23], v3, s[24:27], s36 offen offset:2048 sc1
    buffer_load_dwordx4 v[28:31], v3, s[24:27], s37 offen offset:0 sc1
    buffer_load_dwordx4 v[36:39], v3, s[24:27], s37 offen offset:2048 sc1
    s_mov_b32 s65, -1
L_eg_106:
    s_waitcnt lgkmcnt(3)
    v_mfma_f32_32x32x16_bf16 v[136:151], v[116:119], v[156:159], v[136:151]
    ds_read_b32 v44, v7 offset:192
    s_waitcnt lgkmcnt(2)
    v_mfma_f32_32x32x16_bf16 v[136:151], v[124:127], v[164:167], v[136:151]
    s_waitcnt lgkmcnt(1)
    v_mfma_f32_32x32x16_bf16 v[136:151], v[132:135], v[160:163], v[136:151]
    s_waitcnt lgkmcnt(0)
    v_cmp_gt_u32 vcc, s65, v44
    s_cbranch_vccnz L_eg_107
    buffer_load_dwordx4 v[12:15], v3, s[24:27], s36 offen offset:0 sc1
    buffer_load_dwordx4 v[20:23], v3, s[24:27], s36 offen offset:2048 sc1
    buffer_load_dwordx4 v[28:31], v3, s[24:27], s37 offen offset:0 sc1
    buffer_load_dwordx4 v[36:39], v3, s[24:27], s37 offen offset:2048 sc1
    s_mov_b32 s65, -1
L_eg_107:
    s_lshl_b32 s34, s62, 12
    s_add_u32 s34, s34, 0x14000
    v_add_u32 v1, s34, v3
    v_lshl_add_u32 v126, s62, 2, v7
    s_cmp_eq_u32 s63, 0
    s_cselect_b32 s62, 1.0, -1.0
    s_mov_b32 s63, s62
    v_and_b32 v2, 31, v0
    s_mov_b32 s64, 0x36000000
    v_lshrrev_b32 v124, 5, v0
    v_lshlrev_b32 v2, 16, v2
    v_lshl_add_u32 v2, v124, 4, v2
    s_mov_b32 s34, 0
    s_cmp_eq_u32 s65, -1
    s_cbranch_scc1 L_gi_108
L_wa_109:
    s_sleep 1
    s_sub_u32 s90, s90, 1
    s_cbranch_scc1 L_exit_2
    ds_read_b32 v152, v7 offset:192
    s_waitcnt lgkmcnt(0)
    v_cmp_gt_u32 vcc, 9, v152
    s_cbranch_vccnz L_wa_109
L_og_110:
    buffer_load_dwordx4 v[12:15], v3, s[24:27], s36 offen offset:0 sc1
    buffer_load_dwordx4 v[20:23], v3, s[24:27], s36 offen offset:2048 sc1
    buffer_load_dwordx4 v[28:31], v3, s[24:27], s37 offen offset:0 sc1
    buffer_load_dwordx4 v[36:39], v3, s[24:27], s37 offen offset:2048 sc1
L_gi_108:
    s_add_u32 s34, s34, 1
    s_waitcnt vmcnt(3)
    ds_write_b128 v6, v[12:15] offset:32768
    v_max3_u32 v152, v12, v13, v14
    v_max_u32 v152, v152, v15
    s_waitcnt vmcnt(2)
    ds_write_b128 v6, v[20:23] offset:33792
    v_max3_u32 v153, v20, v21, v22
    v_max_u32 v153, v153, v23
    s_waitcnt vmcnt(1)
    ds_write_b128 v6, v[28:31] offset:34816
    v_max3_u32 v154, v28, v29, v30
    v_max_u32 v154, v154, v31
    s_waitcnt vmcnt(0)
    ds_write_b128 v6, v[36:39] offset:35840
    v_max3_u32 v155, v36, v37, v38
    v_max_u32 v155, v155, v39
    v_max3_u32 v152, v152, v153, v154
    v_max_u32 v152, v152, v155
    v_cmp_eq_u32 vcc, -1, v152
    s_cbranch_vccz L_oh_111
    s_cmp_lt_u32 s34, 0x20000
    s_cbranch_scc1 L_og_110
L_oh_111:
    v_fma_f32 v52, -v52, s64, s64
    v_mov_b32 v5, 2
    s_mov_b64 exec, 1
    ds_write_b32 v4, v5 offset:240
    s_mov_b64 exec, -1
L_sy_112:
    ds_read_b32 v164, v7 offset:240
    s_waitcnt lgkmcnt(0)
    v_cmp_gt_u32 vcc, 2, v164
    s_cbranch_vccz L_sz_113
    s_sub_u32 s90, s90, 1
    s_cbranch_scc0 L_sy_112
    s_branch L_exit_2
L_sz_113:
    ds_read_b128 v[152:155], v3 offset:32768
    ds_read_b128 v[156:159], v3 offset:33792
    ds_read_b128 v[164:167], v3 offset:34816
    ds_read_b128 v[160:163], v3 offset:35840
    s_waitcnt lgkmcnt(3)
    v_mfma_f32_32x32x16_bf16 v[136:151], v[8:11], v[152:155], v[136:151]
    ds_read_b128 v[152:155], v3 offset:36864
    s_waitcnt lgkmcnt(3)
    v_mfma_f32_32x32x16_bf16 v[136:151], v[16:19], v[156:159], v[136:151]
    ds_read_b128 v[156:159], v3 offset:37888
    s_waitcnt lgkmcnt(3)
    v_mfma_f32_32x32x16_bf16 v[136:151], v[24:27], v[164:167], v[136:151]
    ds_read_b128 v[164:167], v3 offset:38912
    s_waitcnt lgkmcnt(3)
    v_mfma_f32_32x32x16_bf16 v[136:151], v[32:35], v[160:163], v[136:151]
    ds_read_b128 v[160:163], v3 offset:39936
    s_waitcnt lgkmcnt(3)
    v_mfma_f32_32x32x16_bf16 v[136:151], v[40:43], v[152:155], v[136:151]
    ds_read_b128 v[152:155], v3 offset:40960
    s_waitcnt lgkmcnt(3)
    v_mfma_f32_32x32x16_bf16 v[136:151], v[48:51], v[156:159], v[136:151]
    ds_read_b128 v[156:159], v3 offset:41984
    s_waitcnt lgkmcnt(3)
    v_mfma_f32_32x32x16_bf16 v[136:151], v[56:59], v[164:167], v[136:151]
    ds_read_b128 v[164:167], v3 offset:43008
    s_waitcnt lgkmcnt(3)
    v_mfma_f32_32x32x16_bf16 v[136:151], v[64:67], v[160:163], v[136:151]
    ds_read_b128 v[160:163], v3 offset:44032
    s_waitcnt lgkmcnt(3)
    v_mfma_f32_32x32x16_bf16 v[136:151], v[72:75], v[152:155], v[136:151]
    ds_read_b128 v[152:155], v3 offset:45056
    s_waitcnt lgkmcnt(3)
    v_mfma_f32_32x32x16_bf16 v[136:151], v[80:83], v[156:159], v[136:151]
    ds_read_b128 v[156:159], v3 offset:46080
    s_waitcnt lgkmcnt(3)
    v_mfma_f32_32x32x16_bf16 v[136:151], v[88:91], v[164:167], v[136:151]
    ds_read_b128 v[164:167], v3 offset:47104
    s_waitcnt lgkmcnt(3)
    v_mfma_f32_32x32x16_bf16 v[136:151], v[96:99], v[160:163], v[136:151]
    ds_read_b128 v[160:163], v3 offset:48128
    ds_read_b32 v124, v126 offset:32
    ds_read_b32 v125, v126 offset:40
    ds_read_b128 v[60:63], v1 offset:0
    ds_read_b128 v[68:71], v1 offset:1024
    ds_read_b128 v[76:79], v1 offset:2048
    ds_read_b128 v[84:87], v1 offset:3072
    ds_read_b128 v[92:95], v1 offset:8192
    ds_read_b128 v[100:103], v1 offset:9216
    ds_read_b128 v[108:111], v1 offset:10240
    ds_read_b128 v[116:119], v1 offset:11264
    s_waitcnt lgkmcnt(13)
    v_mfma_f32_32x32x16_bf16 v[136:151], v[104:107], v[152:155], v[136:151]
    s_waitcnt lgkmcnt(12)
    v_mfma_f32_32x32x16_bf16 v[136:151], v[112:115], v[156:159], v[136:151]
    s_waitcnt lgkmcnt(11)
    v_mfma_f32_32x32x16_bf16 v[136:151], v[120:123], v[164:167], v[136:151]
    s_waitcnt lgkmcnt(10)
    v_mfma_f32_32x32x16_bf16 v[136:151], v[128:131], v[160:163], v[136:151]
    s_waitcnt lgkmcnt(0)
L_yd_114:
    v_min_u32 v124, v124, v125
    s_nop 0
    v_readfirstlane_b32 s35, v124
    s_cmp_eq_u32 s35, 7
    s_cbranch_scc1 L_yo_115
    s_sub_u32 s90, s90, 1
    s_cbranch_scc1 L_exit_2
    ds_read_b32 v124, v126 offset:32
    ds_read_b32 v125, v126 offset:40
    ds_read_b128 v[60:63], v1 offset:0
    ds_read_b128 v[68:71], v1 offset:1024
    ds_read_b128 v[76:79], v1 offset:2048
    ds_read_b128 v[84:87], v1 offset:3072
    ds_read_b128 v[92:95], v1 offset:8192
    ds_read_b128 v[100:103], v1 offset:9216
    ds_read_b128 v[108:111], v1 offset:10240
    ds_read_b128 v[116:119], v1 offset:11264
    s_waitcnt lgkmcnt(0)
    s_branch L_yd_114
L_yo_115:
    v_pk_fma_f32 v[60:61], v[92:93], s[62:63], v[60:61]
    v_pk_fma_f32 v[62:63], v[94:95], s[62:63], v[62:63]
    v_pk_fma_f32 v[68:69], v[100:101], s[62:63], v[68:69]
    v_pk_fma_f32 v[70:71], v[102:103], s[62:63], v[70:71]
    v_pk_fma_f32 v[76:77], v[108:109], s[62:63], v[76:77]
    v_pk_fma_f32 v[78:79], v[110:111], s[62:63], v[78:79]
    v_pk_fma_f32 v[84:85], v[116:117], s[62:63], v[84:85]
    v_pk_fma_f32 v[86:87], v[118:119], s[62:63], v[86:87]
    s_nop 3
    v_pk_fma_f32 v[136:137], v[60:61], v[52:53], v[136:137] op_sel_hi:[1,0,1]
    v_pk_fma_f32 v[138:139], v[62:63], v[52:53], v[138:139] op_sel_hi:[1,0,1]
    v_pk_fma_f32 v[140:141], v[68:69], v[52:53], v[140:141] op_sel_hi:[1,0,1]
    v_pk_fma_f32 v[142:143], v[70:71], v[52:53], v[142:143] op_sel_hi:[1,0,1]
    v_pk_fma_f32 v[144:145], v[76:77], v[52:53], v[144:145] op_sel_hi:[1,0,1]
    v_pk_fma_f32 v[146:147], v[78:79], v[52:53], v[146:147] op_sel_hi:[1,0,1]
    v_pk_fma_f32 v[148:149], v[84:85], v[52:53], v[148:149] op_sel_hi:[1,0,1]
    v_pk_fma_f32 v[150:151], v[86:87], v[52:53], v[150:151] op_sel_hi:[1,0,1]
    v_cvt_pk_bf16_f32 v40, v136, v137
    v_cvt_pk_bf16_f32 v41, v138, v139
    v_cvt_pk_bf16_f32 v42, v140, v141
    v_cvt_pk_bf16_f32 v43, v142, v143
    v_cvt_pk_bf16_f32 v44, v144, v145
    v_cvt_pk_bf16_f32 v45, v146, v147
    v_cvt_pk_bf16_f32 v46, v148, v149
    v_cvt_pk_bf16_f32 v47, v150, v151
    v_permlane32_swap_b32 v40, v42
    v_permlane32_swap_b32 v41, v43
    s_nop 0
    v_permlane32_swap_b32 v44, v46
    v_permlane32_swap_b32 v45, v47
    buffer_store_dwordx4 v[40:43], v2, s[80:83], s61 offen nt
    buffer_store_dwordx4 v[44:47], v2, s[80:83], s61 offen offset:32 nt
    s_branch L_end_1
L_z0_83:
    s_mov_b32 s3, 0x24400
    v_lshl_add_u32 v160, v152, 2, s3
    v_subrev_u32 v149, 9216, v149
    v_subrev_u32 v148, 9216, v148
    v_add_u32 v150, 0x2000, v150
    v_add_u32 v151, 0x2000, v151
    s_nop 1
    v_cvt_pk_bf16_f32 v72, v104, v108
    ds_write_b32 v160, v72 offset:0
    v_cvt_pk_bf16_f32 v73, v105, v109
    ds_write_b32 v160, v73 offset:128
    v_cvt_pk_bf16_f32 v74, v106, v110
    ds_write_b32 v160, v74 offset:256
    v_cvt_pk_bf16_f32 v75, v107, v111
    ds_write_b32 v160, v75 offset:384
    v_cvt_pk_bf16_f32 v76, v112, v116
    ds_write_b32 v160, v76 offset:64
    v_cvt_pk_bf16_f32 v77, v113, v117
    ds_write_b32 v160, v77 offset:192
    v_cvt_pk_bf16_f32 v78, v114, v118
    ds_write_b32 v160, v78 offset:320
    v_cvt_pk_bf16_f32 v79, v115, v119
    ds_write_b32 v160, v79 offset:448
    s_mov_b64 exec, 1
    ds_write_b32 v4, v5 offset:144
    s_mov_b64 exec, -1
    v_sub_u32 v80, 2048, v152
    v_and_b32 v80, 0x7ff, v80
    v_lshl_add_u32 v80, v80, 2, s3
    v_sub_u32 v81, 2016, v152
    v_and_b32 v81, 0x7ff, v81
    v_lshl_add_u32 v81, v81, 2, s3
    v_sub_u32 v82, 1984, v152
    v_and_b32 v82, 0x7ff, v82
    v_lshl_add_u32 v82, v82, 2, s3
    v_sub_u32 v83, 1952, v152
    v_and_b32 v83, 0x7ff, v83
    v_lshl_add_u32 v83, v83, 2, s3
    v_sub_u32 v84, 2032, v152
    v_and_b32 v84, 0x7ff, v84
    v_lshl_add_u32 v84, v84, 2, s3
    v_sub_u32 v85, 2000, v152
    v_and_b32 v85, 0x7ff, v85
    v_lshl_add_u32 v85, v85, 2, s3
    v_sub_u32 v86, 1968, v152
    v_and_b32 v86, 0x7ff, v86
    v_lshl_add_u32 v86, v86, 2, s3
    v_sub_u32 v87, 1936, v152
    v_and_b32 v87, 0x7ff, v87
    v_lshl_add_u32 v87, v87, 2, s3
L_sy_116:
    ds_read_b32 v164, v7 offset:144
    s_waitcnt lgkmcnt(0)
    v_cmp_gt_u32 vcc, 1, v164
    s_cbranch_vccz L_sz_117
    s_sleep 1
    s_sub_u32 s90, s90, 1
    s_cbranch_scc0 L_sy_116
    s_branch L_exit_2
L_sz_117:
    ds_read_b32 v72, v80
    ds_read_b32 v73, v81
    ds_read_b32 v74, v82
    ds_read_b32 v75, v83
    ds_read_b32 v76, v84
    ds_read_b32 v77, v85
    ds_read_b32 v78, v86
    ds_read_b32 v79, v87
    s_waitcnt vmcnt(0)
    s_waitcnt lgkmcnt(0)
    v_lshlrev_b32 v161, 16, v72
    v_and_b32 v162, 0xffff0000, v72
    v_mul_f32 v80, v8, v104
    v_mul_f32 v84, v8, v108
    v_fma_f32 v80, -v9, v108, v80
    v_fma_f32 v84, v9, v104, v84
    v_fma_f32 v80, v10, v161, v80
    v_fma_f32 v84, -v10, v162, v84
    v_fma_f32 v80, v11, v162, v80
    v_fma_f32 v84, v11, v161, v84
    v_lshlrev_b32 v161, 16, v73
    v_and_b32 v162, 0xffff0000, v73
    v_mul_f32 v81, v12, v105
    v_mul_f32 v85, v12, v109
    v_fma_f32 v81, -v13, v109, v81
    v_fma_f32 v85, v13, v105, v85
    v_fma_f32 v81, v14, v161, v81
    v_fma_f32 v85, -v14, v162, v85
    v_fma_f32 v81, v15, v162, v81
    v_fma_f32 v85, v15, v161, v85
    v_lshlrev_b32 v161, 16, v74
    v_and_b32 v162, 0xffff0000, v74
    v_mul_f32 v82, v16, v106
    v_mul_f32 v86, v16, v110
    v_fma_f32 v82, -v17, v110, v82
    v_fma_f32 v86, v17, v106, v86
    v_fma_f32 v82, v18, v161, v82
    v_fma_f32 v86, -v18, v162, v86
    v_fma_f32 v82, v19, v162, v82
    v_fma_f32 v86, v19, v161, v86
    v_lshlrev_b32 v161, 16, v75
    v_and_b32 v162, 0xffff0000, v75
    v_mul_f32 v83, v20, v107
    v_mul_f32 v87, v20, v111
    v_fma_f32 v83, -v21, v111, v83
    v_fma_f32 v87, v21, v107, v87
    v_fma_f32 v83, v22, v161, v83
    v_fma_f32 v87, -v22, v162, v87
    v_fma_f32 v83, v23, v162, v83
    v_fma_f32 v87, v23, v161, v87
    v_lshlrev_b32 v161, 16, v76
    v_and_b32 v162, 0xffff0000, v76
    v_mul_f32 v96, v24, v112
    v_mul_f32 v100, v24, v116
    v_fma_f32 v96, -v25, v116, v96
    v_fma_f32 v100, v25, v112, v100
    v_fma_f32 v96, v26, v161, v96
    v_fma_f32 v100, -v26, v162, v100
    v_fma_f32 v96, v27, v162, v96
    v_fma_f32 v100, v27, v161, v100
    v_lshlrev_b32 v161, 16, v77
    v_and_b32 v162, 0xffff0000, v77
    v_mul_f32 v97, v28, v113
    v_mul_f32 v101, v28, v117
    v_fma_f32 v97, -v29, v117, v97
    v_fma_f32 v101, v29, v113, v101
    v_fma_f32 v97, v30, v161, v97
    v_fma_f32 v101, -v30, v162, v101
    v_fma_f32 v97, v31, v162, v97
    v_fma_f32 v101, v31, v161, v101
    v_lshlrev_b32 v161, 16, v78
    v_and_b32 v162, 0xffff0000, v78
    v_mul_f32 v98, v32, v114
    v_mul_f32 v102, v32, v118
    v_fma_f32 v98, -v33, v118, v98
    v_fma_f32 v102, v33, v114, v102
    v_fma_f32 v98, v34, v161, v98
    v_fma_f32 v102, -v34, v162, v102
    v_fma_f32 v98, v35, v162, v98
    v_fma_f32 v102, v35, v161, v102
    v_lshlrev_b32 v161, 16, v79
    v_and_b32 v162, 0xffff0000, v79
    v_mul_f32 v99, v36, v115
    v_mul_f32 v103, v36, v119
    v_fma_f32 v99, -v37, v119, v99
    v_fma_f32 v103, v37, v115, v103
    v_fma_f32 v99, v38, v161, v99
    v_fma_f32 v103, -v38, v162, v103
    v_fma_f32 v99, v39, v162, v99
    v_fma_f32 v103, v39, v161, v103
    buffer_load_dwordx4 v[8:11], v3, s[24:27], s30 offen offset:0 sc1
    buffer_load_dwordx4 v[12:15], v3, s[24:27], s30 offen offset:1024 sc1
    buffer_load_dwordx4 v[16:19], v3, s[24:27], s30 offen offset:2048 sc1
    buffer_load_dwordx4 v[20:23], v3, s[24:27], s30 offen offset:3072 sc1
    buffer_load_dwordx4 v[24:27], v3, s[24:27], s23 offen offset:0 sc1
    buffer_load_dwordx4 v[28:31], v3, s[24:27], s23 offen offset:1024 sc1
    buffer_load_dwordx4 v[32:35], v3, s[24:27], s23 offen offset:2048 sc1
    buffer_load_dwordx4 v[36:39], v3, s[24:27], s23 offen offset:3072 sc1
    s_branch L_zr_84
L_end_1:
L_exit_2:
    s_endpgm
L_code_end:
.section .rodata,"a"
.p2align 6
.amdhsa_kernel fused_kernel
  .amdhsa_next_free_vgpr 168
  .amdhsa_next_free_sgpr 102
  .amdhsa_accum_offset 168
  .amdhsa_group_segment_fixed_size 0
  .amdhsa_kernarg_size 96
  .amdhsa_user_sgpr_count 2
  .amdhsa_user_sgpr_kernarg_segment_ptr 1
  .amdhsa_system_sgpr_workgroup_id_x 1
.end_amdhsa_kernel
```
